```python
import torch

def _softmax(x, axis=-1):
    return torch.softmax(x, dim=axis)
def _gelu(x):
    return torch.nn.functional.gelu(x, approximate="tanh")
def _silu(x):
    return torch.nn.functional.silu(x)
def _sigmoid(x):
    return torch.sigmoid(x)
def _layernorm(x, axis=-1, eps=1e-5):
    m = x.mean(dim=axis, keepdim=True)
    v = x.var(dim=axis, keepdim=True, unbiased=False)
    return (x - m) / torch.sqrt(v + eps)
def _scatter_add(tgt, idx, src, axis=0):
    return tgt.clone().index_add_(axis, idx, src)
def _segment_sum(src, seg, n):
    out = torch.zeros((n,) + src.shape[1:], dtype=src.dtype)
    return out.index_add_(0, seg, src)
def _pad(x, pw):
    flat = tuple(v for pair in reversed(pw) for v in pair)
    return torch.nn.functional.pad(x, flat)

kernel_name = 'standalone__gqa_block_cached__decode'

def setup_inputs():

    _w = (lambda a: (lambda t: t.to(torch.bfloat16) if t.is_floating_point() else t)(torch.as_tensor(a)))
    B, Sq, D = 2, 1, 1024
    Hq, Hkv, Sk, Dh = 32, 4, 32768, 128
    assert Hq % Hkv == 0, (Hq, Hkv)
    return {
        "x": _w((lambda *s: torch.randn(*s, dtype=torch.bfloat16) * 0.8)(B, Sq, D)),
        "k_cache": _w((lambda *s: torch.randn(*s, dtype=torch.bfloat16) * 0.8)(B, Hkv, Sk, Dh)),
        "v_cache": _w((lambda *s: torch.randn(*s, dtype=torch.bfloat16) * 0.05)(B, Hkv, Sk, Dh)),
        "wq": _w((lambda *s: torch.randn(*s, dtype=torch.bfloat16) * 0.8)(D, Hq * Dh) * (D ** -0.5)),
        "wo": _w((lambda *s: torch.randn(*s, dtype=torch.bfloat16) * 0.05)(Hq * Dh, D) * ((Hq * Dh) ** -0.5)),
    }

def reference(x, k_cache, v_cache, wq, wo):
    B, Sq, D = x.shape
    Hq, Dh = 32, 128
    Hkv = k_cache.shape[1]
    rep = Hq // Hkv
    q = (lambda x, *d: x.permute(*d))((x @ wq).reshape(B, Sq, Hq, Dh), 0, 2, 1, 3)
    k = (lambda x, n, axis: torch.repeat_interleave(x, n, dim=axis))(k_cache, rep, axis=1)
    v = (lambda x, n, axis: torch.repeat_interleave(x, n, dim=axis))(v_cache, rep, axis=1)
    scores = torch.einsum("bhqd,bhkd->bhqk", q, k) * (Dh ** -0.5)
    p = _softmax(scores, axis=-1)
    o = torch.einsum("bhqk,bhkd->bhqd", p, v)
    return (lambda x, *d: x.permute(*d))(o, 0, 2, 1, 3).reshape(B, Sq, Hq * Dh) @ wo
```

```asm
; @launch grid=(256,1,1) block=(512,1,1) lds=139264
.amdgcn_target "amdgcn-amd-amdhsa--gfx950"
.text
.globl standalone__gqa_block_cached__decode_kernel
.p2align 8
.type standalone__gqa_block_cached__decode_kernel,@function
standalone__gqa_block_cached__decode_kernel:
    s_cmp_ge_u32 s2, 256
    s_cbranch_scc1 L_done
    s_load_dwordx16 s[4:19], s[0:1], 0
    s_mov_b32 s90, 0x05040100
    s_mov_b32 s91, 0x07060302
    v_lshrrev_b32 v1, 6, v0
    s_lshr_b32 s20, s2, 6
    s_bfe_u32 s21, s2, 0x10005
    v_readfirstlane_b32 s23, v1
    s_and_b32 s22, s2, 31
    v_and_b32 v0, 63, v0
    v_and_b32 v3, 15, v0
    v_lshrrev_b32 v4, 4, v0
    s_mov_b32 s27, s23
    s_cmp_ge_u32 s23, 4
    s_cbranch_scc1 L_helper
    v_lshlrev_b32 v1, 4, v3
    v_lshl_add_u32 v1, v4, 10, v1
    s_lshl_b32 s51, s21, 2
    s_add_u32 s51, s51, s20
    s_lshl_b32 s52, s51, 19
    s_mov_b32 s53, s52
    s_add_u32 s55, s51, 12
    s_lshl_b32 s51, s51, 23
    s_lshl_b32 s25, s23, 12
    s_add_u32 s54, s51, s25
    s_mov_b32 s58, 2
    s_lshl_b32 s25, s22, 2
    s_add_u32 s25, s25, s23
    s_lshl_b32 s25, s25, 12
    s_add_u32 s51, s51, s25
    s_add_u32 s24, s51, s52
    s_mov_b32 s25, s24
    s_lshl_b32 s50, s23, 15
    v_lshlrev_b32 v5, 8, v4
    v_lshlrev_b32 v6, 8, v3
    v_add_u32 v6, s50, v6
    v_add_u32 v7, 0, v4
    v_xor_b32 v7, v7, v3
    v_lshl_add_u32 v8, v7, 4, v5
    v_lshl_add_u32 v12, v7, 4, v6
    v_add_u32 v7, 4, v4
    v_xor_b32 v7, v7, v3
    v_lshl_add_u32 v9, v7, 4, v5
    v_lshl_add_u32 v13, v7, 4, v6
    v_add_u32 v7, 8, v4
    v_xor_b32 v7, v7, v3
    v_lshl_add_u32 v10, v7, 4, v5
    v_lshl_add_u32 v14, v7, 4, v6
    v_add_u32 v7, 12, v4
    v_xor_b32 v7, v7, v3
    v_lshl_add_u32 v11, v7, 4, v5
    v_lshl_add_u32 v15, v7, 4, v6
    s_waitcnt lgkmcnt(0)
    s_mov_b32 s28, s6
    s_and_b32 s29, s7, 0xffff
    s_mov_b32 s30, 0x4000000
    s_mov_b32 s31, 0x20000
    s_mov_b32 s32, s8
    s_and_b32 s33, s9, 0xffff
    s_mov_b32 s34, 0x4000000
    s_mov_b32 s35, 0x20000
    s_mov_b32 s36, s18
    s_and_b32 s37, s19, 0xffff
    s_mov_b32 s38, 0x24c000
    s_mov_b32 s39, 0x20000
    s_add_u32 m0, s50, 0
    s_nop 0
    buffer_load_dwordx4 v8, s[28:31], s24 offen offset:0 nt lds
    buffer_load_dwordx4 v9, s[28:31], s24 offen offset:1024 nt lds
    s_barrier
    buffer_load_dwordx4 v10, s[28:31], s24 offen offset:2048 nt lds
    buffer_load_dwordx4 v11, s[28:31], s24 offen offset:3072 nt lds
    s_add_u32 s52, s52, 0x80000
    s_and_b32 s52, s52, 0x7fffff
    s_add_u32 s24, s51, s52
    s_add_u32 m0, s50, 4096
    s_nop 0
    buffer_load_dwordx4 v8, s[28:31], s24 offen offset:0 nt lds
    buffer_load_dwordx4 v9, s[28:31], s24 offen offset:1024 nt lds
    s_waitcnt vmcnt(4)
    buffer_load_dwordx4 v10, s[28:31], s24 offen offset:2048 nt lds
    buffer_load_dwordx4 v11, s[28:31], s24 offen offset:3072 nt lds
    s_add_u32 s52, s52, 0x80000
    s_and_b32 s52, s52, 0x7fffff
    s_add_u32 s24, s51, s52
    s_waitcnt vmcnt(4)
    s_add_u32 m0, s50, 8192
    s_nop 0
    buffer_load_dwordx4 v8, s[28:31], s24 offen offset:0 nt lds
    buffer_load_dwordx4 v9, s[28:31], s24 offen offset:1024 nt lds
    s_waitcnt vmcnt(4)
    buffer_load_dwordx4 v10, s[28:31], s24 offen offset:2048 nt lds
    buffer_load_dwordx4 v11, s[28:31], s24 offen offset:3072 nt lds
    s_add_u32 s52, s52, 0x80000
    s_and_b32 s52, s52, 0x7fffff
    s_add_u32 s24, s51, s52
    s_waitcnt vmcnt(4)
    s_add_u32 m0, s50, 12288
    s_nop 0
    buffer_load_dwordx4 v8, s[28:31], s24 offen offset:0 nt lds
    buffer_load_dwordx4 v9, s[28:31], s24 offen offset:1024 nt lds
    s_waitcnt vmcnt(4)
    buffer_load_dwordx4 v10, s[28:31], s24 offen offset:2048 nt lds
    buffer_load_dwordx4 v11, s[28:31], s24 offen offset:3072 nt lds
    s_add_u32 s52, s52, 0x80000
    s_and_b32 s52, s52, 0x7fffff
    s_add_u32 s24, s51, s52
    v_mov_b32 v2, 135172
    v_mov_b32 v5, 1
    ds_write_b32 v2, v5
    s_waitcnt vmcnt(4)
    s_add_u32 m0, s50, 16384
    s_nop 0
    buffer_load_dwordx4 v8, s[28:31], s24 offen offset:0 nt lds
    buffer_load_dwordx4 v9, s[28:31], s24 offen offset:1024 nt lds
    s_waitcnt vmcnt(4)
    buffer_load_dwordx4 v10, s[28:31], s24 offen offset:2048 nt lds
    buffer_load_dwordx4 v11, s[28:31], s24 offen offset:3072 nt lds
    s_add_u32 s52, s52, 0x80000
    s_and_b32 s52, s52, 0x7fffff
    s_add_u32 s24, s51, s52
    s_waitcnt vmcnt(4)
    s_add_u32 m0, s50, 20480
    s_nop 0
    buffer_load_dwordx4 v8, s[28:31], s24 offen offset:0 nt lds
    buffer_load_dwordx4 v9, s[28:31], s24 offen offset:1024 nt lds
    s_waitcnt vmcnt(4)
    buffer_load_dwordx4 v10, s[28:31], s24 offen offset:2048 nt lds
    buffer_load_dwordx4 v11, s[28:31], s24 offen offset:3072 nt lds
    s_add_u32 s52, s52, 0x80000
    s_and_b32 s52, s52, 0x7fffff
    s_add_u32 s24, s51, s52
    s_waitcnt vmcnt(4)
    s_add_u32 m0, s50, 24576
    s_nop 0
    buffer_load_dwordx4 v8, s[28:31], s24 offen offset:0 nt lds
    buffer_load_dwordx4 v9, s[28:31], s24 offen offset:1024 nt lds
    s_waitcnt vmcnt(4)
    buffer_load_dwordx4 v10, s[28:31], s24 offen offset:2048 nt lds
    buffer_load_dwordx4 v11, s[28:31], s24 offen offset:3072 nt lds
    s_add_u32 s52, s52, 0x80000
    s_and_b32 s52, s52, 0x7fffff
    s_add_u32 s24, s51, s52
    s_waitcnt vmcnt(4)
    s_add_u32 m0, s50, 28672
    s_nop 0
    buffer_load_dwordx4 v8, s[28:31], s24 offen offset:0 nt lds
    buffer_load_dwordx4 v9, s[28:31], s24 offen offset:1024 nt lds
    s_waitcnt vmcnt(4)
    buffer_load_dwordx4 v10, s[28:31], s24 offen offset:2048 nt lds
    buffer_load_dwordx4 v11, s[28:31], s24 offen offset:3072 nt lds
    s_add_u32 s52, s52, 0x80000
    s_and_b32 s52, s52, 0x7fffff
    s_add_u32 s24, s51, s52
    s_waitcnt vmcnt(8)
    buffer_load_dwordx4 v[128:131], v1, s[32:35], s25 offen offset:0 nt
    buffer_load_dwordx4 v[132:135], v1, s[32:35], s25 offen offset:256 nt
    s_waitcnt vmcnt(8)
    buffer_load_dwordx4 v[136:139], v1, s[32:35], s25 offen offset:512 nt
    buffer_load_dwordx4 v[140:143], v1, s[32:35], s25 offen offset:768 nt
    s_add_u32 s53, s53, 0x80000
    s_and_b32 s53, s53, 0x7fffff
    s_add_u32 s25, s51, s53
    s_waitcnt vmcnt(8)
    buffer_load_dwordx4 v[144:147], v1, s[32:35], s25 offen offset:0 nt
    buffer_load_dwordx4 v[148:151], v1, s[32:35], s25 offen offset:256 nt
    s_waitcnt vmcnt(8)
    buffer_load_dwordx4 v[152:155], v1, s[32:35], s25 offen offset:512 nt
    buffer_load_dwordx4 v[156:159], v1, s[32:35], s25 offen offset:768 nt
    s_add_u32 s53, s53, 0x80000
    s_and_b32 s53, s53, 0x7fffff
    s_add_u32 s25, s51, s53
    s_waitcnt vmcnt(8)
    buffer_load_dwordx4 v[160:163], v1, s[32:35], s25 offen offset:0 nt
    buffer_load_dwordx4 v[164:167], v1, s[32:35], s25 offen offset:256 nt
    s_waitcnt vmcnt(8)
    buffer_load_dwordx4 v[168:171], v1, s[32:35], s25 offen offset:512 nt
    buffer_load_dwordx4 v[172:175], v1, s[32:35], s25 offen offset:768 nt
    s_add_u32 s53, s53, 0x80000
    s_and_b32 s53, s53, 0x7fffff
    s_add_u32 s25, s51, s53
    s_waitcnt vmcnt(8)
    buffer_load_dwordx4 v[176:179], v1, s[32:35], s25 offen offset:0 nt
    buffer_load_dwordx4 v[180:183], v1, s[32:35], s25 offen offset:256 nt
    s_waitcnt vmcnt(8)
    buffer_load_dwordx4 v[184:187], v1, s[32:35], s25 offen offset:512 nt
    buffer_load_dwordx4 v[188:191], v1, s[32:35], s25 offen offset:768 nt
    s_add_u32 s53, s53, 0x80000
    s_and_b32 s53, s53, 0x7fffff
    s_add_u32 s25, s51, s53
    s_waitcnt vmcnt(8)
    buffer_load_dwordx4 v[192:195], v1, s[32:35], s25 offen offset:0 nt
    buffer_load_dwordx4 v[196:199], v1, s[32:35], s25 offen offset:256 nt
    s_waitcnt vmcnt(8)
    buffer_load_dwordx4 v[200:203], v1, s[32:35], s25 offen offset:512 nt
    buffer_load_dwordx4 v[204:207], v1, s[32:35], s25 offen offset:768 nt
    s_add_u32 s53, s53, 0x80000
    s_and_b32 s53, s53, 0x7fffff
    s_add_u32 s25, s51, s53
    s_waitcnt vmcnt(8)
    buffer_load_dwordx4 v[208:211], v1, s[32:35], s25 offen offset:0 nt
    buffer_load_dwordx4 v[212:215], v1, s[32:35], s25 offen offset:256 nt
    s_waitcnt vmcnt(8)
    buffer_load_dwordx4 v[216:219], v1, s[32:35], s25 offen offset:512 nt
    buffer_load_dwordx4 v[220:223], v1, s[32:35], s25 offen offset:768 nt
    s_add_u32 s53, s53, 0x80000
    s_and_b32 s53, s53, 0x7fffff
    s_add_u32 s25, s51, s53
    s_waitcnt vmcnt(8)
    buffer_load_dwordx4 v[224:227], v1, s[32:35], s25 offen offset:0 nt
    buffer_load_dwordx4 v[228:231], v1, s[32:35], s25 offen offset:256 nt
    s_waitcnt vmcnt(8)
    buffer_load_dwordx4 v[232:235], v1, s[32:35], s25 offen offset:512 nt
    buffer_load_dwordx4 v[236:239], v1, s[32:35], s25 offen offset:768 nt
    s_add_u32 s53, s53, 0x80000
    s_and_b32 s53, s53, 0x7fffff
    s_add_u32 s25, s51, s53
    s_waitcnt vmcnt(8)
    buffer_load_dwordx4 v[240:243], v1, s[32:35], s25 offen offset:0 nt
    buffer_load_dwordx4 v[244:247], v1, s[32:35], s25 offen offset:256 nt
    s_waitcnt vmcnt(8)
    buffer_load_dwordx4 v[248:251], v1, s[32:35], s25 offen offset:512 nt
    buffer_load_dwordx4 v[252:255], v1, s[32:35], s25 offen offset:768 nt
    s_add_u32 s53, s53, 0x80000
    s_and_b32 s53, s53, 0x7fffff
    s_add_u32 s25, s51, s53
    v_mov_b32 v16, 0
    v_mov_b32 v17, 0
    v_mov_b32 v18, 0
    v_mov_b32 v19, 0
    v_mov_b32 v20, 0
    v_mov_b32 v21, 0
    v_mov_b32 v22, 0
    v_mov_b32 v23, 0
    v_mov_b32 v24, 0
    v_mov_b32 v25, 0
    v_mov_b32 v26, 0
    v_mov_b32 v27, 0
    v_mov_b32 v28, 0
    v_mov_b32 v29, 0
    v_mov_b32 v30, 0
    v_mov_b32 v31, 0
    v_lshlrev_b32 v7, 8, v3
    v_lshl_add_u32 v7, v4, 4, v7
    v_add_u32 v7, 131072, v7
    s_mov_b32 s40, 0x00ff00ff
    s_mov_b32 s41, 0x00ff00ff
    s_mov_b32 s42, 0x3e0293ee
    s_barrier
    s_mov_b64 exec, s[40:41]
    ds_read_b128 v[16:19], v7 offset:0
    ds_read_b128 v[20:23], v7 offset:64
    ds_read_b128 v[24:27], v7 offset:128
    ds_read_b128 v[28:31], v7 offset:192
    s_mov_b64 exec, -1
    s_waitcnt lgkmcnt(0)
    s_waitcnt vmcnt(56)
    ds_read_b128 v[96:99], v12 offset:0
    ds_read_b128 v[100:103], v13 offset:0
    ds_read_b128 v[104:107], v14 offset:0
    ds_read_b128 v[108:111], v15 offset:0
    ds_read_b128 v[112:115], v12 offset:4096
    ds_read_b128 v[116:119], v13 offset:4096
    ds_read_b128 v[120:123], v14 offset:4096
    ds_read_b128 v[124:127], v15 offset:4096
    s_waitcnt lgkmcnt(4)
    v_mfma_f32_16x16x32_bf16 v[32:35], v[96:99], v[16:19], 0
    v_mfma_f32_16x16x32_bf16 v[32:35], v[100:103], v[20:23], v[32:35]
    v_mfma_f32_16x16x32_bf16 v[32:35], v[104:107], v[24:27], v[32:35]
    v_mfma_f32_16x16x32_bf16 v[32:35], v[108:111], v[28:31], v[32:35]
    s_waitcnt lgkmcnt(0)
    v_mfma_f32_16x16x32_bf16 v[36:39], v[112:115], v[16:19], 0
    v_mfma_f32_16x16x32_bf16 v[36:39], v[116:119], v[20:23], v[36:39]
    v_mfma_f32_16x16x32_bf16 v[36:39], v[120:123], v[24:27], v[36:39]
    v_mfma_f32_16x16x32_bf16 v[36:39], v[124:127], v[28:31], v[36:39]
    s_waitcnt vmcnt(8)
    s_add_u32 m0, s50, 0
    s_nop 0
    buffer_load_dwordx4 v8, s[28:31], s24 offen offset:0 nt lds
    buffer_load_dwordx4 v9, s[28:31], s24 offen offset:1024 nt lds
    s_waitcnt vmcnt(50)
    ds_read_b128 v[96:99], v12 offset:8192
    ds_read_b128 v[100:103], v13 offset:8192
    ds_read_b128 v[104:107], v14 offset:8192
    ds_read_b128 v[108:111], v15 offset:8192
    ds_read_b128 v[112:115], v12 offset:12288
    ds_read_b128 v[116:119], v13 offset:12288
    ds_read_b128 v[120:123], v14 offset:12288
    ds_read_b128 v[124:127], v15 offset:12288
    s_waitcnt lgkmcnt(4)
    v_mfma_f32_16x16x32_bf16 v[40:43], v[96:99], v[16:19], 0
    v_mfma_f32_16x16x32_bf16 v[40:43], v[100:103], v[20:23], v[40:43]
    v_mfma_f32_16x16x32_bf16 v[40:43], v[104:107], v[24:27], v[40:43]
    v_mfma_f32_16x16x32_bf16 v[40:43], v[108:111], v[28:31], v[40:43]
    s_waitcnt vmcnt(8)
    buffer_load_dwordx4 v10, s[28:31], s24 offen offset:2048 nt lds
    buffer_load_dwordx4 v11, s[28:31], s24 offen offset:3072 nt lds
    s_add_u32 s52, s52, 0x80000
    s_and_b32 s52, s52, 0x7fffff
    s_add_u32 s24, s51, s52
    s_waitcnt lgkmcnt(0)
    v_mfma_f32_16x16x32_bf16 v[44:47], v[112:115], v[16:19], 0
    v_mfma_f32_16x16x32_bf16 v[44:47], v[116:119], v[20:23], v[44:47]
    v_mfma_f32_16x16x32_bf16 v[44:47], v[120:123], v[24:27], v[44:47]
    v_mfma_f32_16x16x32_bf16 v[44:47], v[124:127], v[28:31], v[44:47]
    s_waitcnt vmcnt(44)
    ds_read_b128 v[96:99], v12 offset:16384
    ds_read_b128 v[100:103], v13 offset:16384
    ds_read_b128 v[104:107], v14 offset:16384
    ds_read_b128 v[108:111], v15 offset:16384
    ds_read_b128 v[112:115], v12 offset:20480
    ds_read_b128 v[116:119], v13 offset:20480
    ds_read_b128 v[120:123], v14 offset:20480
    ds_read_b128 v[124:127], v15 offset:20480
    s_waitcnt vmcnt(8)
    s_add_u32 m0, s50, 4096
    s_nop 0
    buffer_load_dwordx4 v8, s[28:31], s24 offen offset:0 nt lds
    buffer_load_dwordx4 v9, s[28:31], s24 offen offset:1024 nt lds
    s_waitcnt lgkmcnt(4)
    v_mfma_f32_16x16x32_bf16 v[48:51], v[96:99], v[16:19], 0
    v_mfma_f32_16x16x32_bf16 v[48:51], v[100:103], v[20:23], v[48:51]
    v_mfma_f32_16x16x32_bf16 v[48:51], v[104:107], v[24:27], v[48:51]
    v_mfma_f32_16x16x32_bf16 v[48:51], v[108:111], v[28:31], v[48:51]
    s_waitcnt lgkmcnt(0)
    v_mfma_f32_16x16x32_bf16 v[52:55], v[112:115], v[16:19], 0
    v_mfma_f32_16x16x32_bf16 v[52:55], v[116:119], v[20:23], v[52:55]
    v_mfma_f32_16x16x32_bf16 v[52:55], v[120:123], v[24:27], v[52:55]
    v_mfma_f32_16x16x32_bf16 v[52:55], v[124:127], v[28:31], v[52:55]
    s_waitcnt vmcnt(38)
    ds_read_b128 v[96:99], v12 offset:24576
    ds_read_b128 v[100:103], v13 offset:24576
    ds_read_b128 v[104:107], v14 offset:24576
    s_waitcnt vmcnt(8)
    buffer_load_dwordx4 v10, s[28:31], s24 offen offset:2048 nt lds
    buffer_load_dwordx4 v11, s[28:31], s24 offen offset:3072 nt lds
    s_add_u32 s52, s52, 0x80000
    s_and_b32 s52, s52, 0x7fffff
    s_add_u32 s24, s51, s52
    ds_read_b128 v[108:111], v15 offset:24576
    ds_read_b128 v[112:115], v12 offset:28672
    ds_read_b128 v[116:119], v13 offset:28672
    ds_read_b128 v[120:123], v14 offset:28672
    ds_read_b128 v[124:127], v15 offset:28672
    s_waitcnt lgkmcnt(4)
    v_mfma_f32_16x16x32_bf16 v[56:59], v[96:99], v[16:19], 0
    v_mfma_f32_16x16x32_bf16 v[56:59], v[100:103], v[20:23], v[56:59]
    v_mfma_f32_16x16x32_bf16 v[56:59], v[104:107], v[24:27], v[56:59]
    v_mfma_f32_16x16x32_bf16 v[56:59], v[108:111], v[28:31], v[56:59]
    s_waitcnt lgkmcnt(0)
    v_mfma_f32_16x16x32_bf16 v[60:63], v[112:115], v[16:19], 0
    v_mfma_f32_16x16x32_bf16 v[60:63], v[116:119], v[20:23], v[60:63]
    v_mfma_f32_16x16x32_bf16 v[60:63], v[120:123], v[24:27], v[60:63]
    v_mfma_f32_16x16x32_bf16 v[60:63], v[124:127], v[28:31], v[60:63]
    s_waitcnt vmcnt(8)
    s_add_u32 m0, s50, 8192
    s_nop 0
    buffer_load_dwordx4 v8, s[28:31], s24 offen offset:0 nt lds
    buffer_load_dwordx4 v9, s[28:31], s24 offen offset:1024 nt lds
    s_nop 7
    v_max3_f32 v6, v32, v33, v34
    v_max3_f32 v7, v35, v36, v37
    v_max3_f32 v6, v6, v38, v39
    v_max3_f32 v7, v7, v40, v41
    v_max3_f32 v6, v6, v42, v43
    v_max3_f32 v7, v7, v44, v45
    v_max3_f32 v6, v6, v46, v47
    v_max3_f32 v7, v7, v48, v49
    v_max3_f32 v6, v6, v50, v51
    v_max3_f32 v7, v7, v52, v53
    v_max3_f32 v6, v6, v54, v55
    v_max3_f32 v7, v7, v56, v57
    v_max3_f32 v6, v6, v58, v59
    v_max3_f32 v7, v7, v60, v61
    v_max3_f32 v6, v6, v62, v63
    v_max_f32 v6, v6, v7
    s_nop 0
    v_mov_b32 v7, v6
    s_nop 1
    v_permlane32_swap_b32 v6, v7
    s_nop 1
    v_max_f32 v6, v6, v7
    s_nop 0
    v_mov_b32 v7, v6
    s_nop 1
    v_permlane16_swap_b32 v6, v7
    s_nop 1
    v_max_f32 v6, v6, v7
    v_mul_f32 v2, s42, v6
    v_mov_b32 v5, 0
    v_mov_b32 v6, 0
    v_fma_f32 v32, v32, s42, -v2
    v_fma_f32 v33, v33, s42, -v2
    v_fma_f32 v34, v34, s42, -v2
    v_fma_f32 v35, v35, s42, -v2
    v_fma_f32 v36, v36, s42, -v2
    v_fma_f32 v37, v37, s42, -v2
    v_fma_f32 v38, v38, s42, -v2
    v_fma_f32 v39, v39, s42, -v2
    v_fma_f32 v40, v40, s42, -v2
    v_fma_f32 v41, v41, s42, -v2
    v_fma_f32 v42, v42, s42, -v2
    v_fma_f32 v43, v43, s42, -v2
    v_fma_f32 v44, v44, s42, -v2
    v_fma_f32 v45, v45, s42, -v2
    v_fma_f32 v46, v46, s42, -v2
    v_fma_f32 v47, v47, s42, -v2
    s_waitcnt vmcnt(8)
    buffer_load_dwordx4 v10, s[28:31], s24 offen offset:2048 nt lds
    buffer_load_dwordx4 v11, s[28:31], s24 offen offset:3072 nt lds
    s_add_u32 s52, s52, 0x80000
    s_and_b32 s52, s52, 0x7fffff
    s_add_u32 s24, s51, s52
    v_fma_f32 v48, v48, s42, -v2
    v_fma_f32 v49, v49, s42, -v2
    v_fma_f32 v50, v50, s42, -v2
    v_fma_f32 v51, v51, s42, -v2
    v_fma_f32 v52, v52, s42, -v2
    v_fma_f32 v53, v53, s42, -v2
    v_fma_f32 v54, v54, s42, -v2
    v_fma_f32 v55, v55, s42, -v2
    v_fma_f32 v56, v56, s42, -v2
    v_fma_f32 v57, v57, s42, -v2
    v_fma_f32 v58, v58, s42, -v2
    v_fma_f32 v59, v59, s42, -v2
    v_fma_f32 v60, v60, s42, -v2
    v_fma_f32 v61, v61, s42, -v2
    v_fma_f32 v62, v62, s42, -v2
    v_fma_f32 v63, v63, s42, -v2
    v_exp_f32 v32, v32
    v_exp_f32 v33, v33
    v_exp_f32 v34, v34
    v_exp_f32 v35, v35
    v_exp_f32 v36, v36
    v_exp_f32 v37, v37
    v_exp_f32 v38, v38
    v_exp_f32 v39, v39
    v_exp_f32 v40, v40
    v_exp_f32 v41, v41
    v_exp_f32 v42, v42
    v_exp_f32 v43, v43
    v_exp_f32 v44, v44
    v_exp_f32 v45, v45
    v_exp_f32 v46, v46
    v_exp_f32 v47, v47
    v_exp_f32 v48, v48
    v_exp_f32 v49, v49
    v_exp_f32 v50, v50
    v_exp_f32 v51, v51
    v_exp_f32 v52, v52
    v_exp_f32 v53, v53
    v_exp_f32 v54, v54
    v_exp_f32 v55, v55
    v_exp_f32 v56, v56
    v_exp_f32 v57, v57
    v_exp_f32 v58, v58
    v_exp_f32 v59, v59
    v_exp_f32 v60, v60
    v_exp_f32 v61, v61
    v_exp_f32 v62, v62
    v_exp_f32 v63, v63
    s_nop 0
    s_waitcnt vmcnt(8)
    s_add_u32 m0, s50, 12288
    s_nop 0
    buffer_load_dwordx4 v8, s[28:31], s24 offen offset:0 nt lds
    buffer_load_dwordx4 v9, s[28:31], s24 offen offset:1024 nt lds
    v_add_f32 v5, v5, v32
    v_add_f32 v6, v6, v33
    v_cvt_pk_bf16_f32 v32, v32, v33
    v_add_f32 v5, v5, v34
    v_add_f32 v6, v6, v35
    v_cvt_pk_bf16_f32 v33, v34, v35
    v_add_f32 v5, v5, v36
    v_add_f32 v6, v6, v37
    v_cvt_pk_bf16_f32 v34, v36, v37
    v_add_f32 v5, v5, v38
    v_add_f32 v6, v6, v39
    v_cvt_pk_bf16_f32 v35, v38, v39
    v_add_f32 v5, v5, v40
    v_add_f32 v6, v6, v41
    v_cvt_pk_bf16_f32 v36, v40, v41
    v_add_f32 v5, v5, v42
    v_add_f32 v6, v6, v43
    v_cvt_pk_bf16_f32 v37, v42, v43
    v_add_f32 v5, v5, v44
    v_add_f32 v6, v6, v45
    v_cvt_pk_bf16_f32 v38, v44, v45
    v_add_f32 v5, v5, v46
    v_add_f32 v6, v6, v47
    v_cvt_pk_bf16_f32 v39, v46, v47
    v_add_f32 v5, v5, v48
    v_add_f32 v6, v6, v49
    v_cvt_pk_bf16_f32 v40, v48, v49
    v_add_f32 v5, v5, v50
    v_add_f32 v6, v6, v51
    v_cvt_pk_bf16_f32 v41, v50, v51
    v_add_f32 v5, v5, v52
    v_add_f32 v6, v6, v53
    v_cvt_pk_bf16_f32 v42, v52, v53
    v_add_f32 v5, v5, v54
    v_add_f32 v6, v6, v55
    v_cvt_pk_bf16_f32 v43, v54, v55
    v_add_f32 v5, v5, v56
    v_add_f32 v6, v6, v57
    v_cvt_pk_bf16_f32 v44, v56, v57
    v_add_f32 v5, v5, v58
    v_add_f32 v6, v6, v59
    v_cvt_pk_bf16_f32 v45, v58, v59
    v_add_f32 v5, v5, v60
    v_add_f32 v6, v6, v61
    v_cvt_pk_bf16_f32 v46, v60, v61
    v_add_f32 v5, v5, v62
    v_add_f32 v6, v6, v63
    v_cvt_pk_bf16_f32 v47, v62, v63
    v_add_f32 v5, v5, v6
    s_waitcnt vmcnt(8)
    buffer_load_dwordx4 v10, s[28:31], s24 offen offset:2048 nt lds
    buffer_load_dwordx4 v11, s[28:31], s24 offen offset:3072 nt lds
    s_add_u32 s52, s52, 0x80000
    s_and_b32 s52, s52, 0x7fffff
    s_add_u32 s24, s51, s52
    s_waitcnt vmcnt(40)
    v_perm_b32 v96, v132, v128, s90
    v_perm_b32 v97, v140, v136, s90
    v_perm_b32 v98, v148, v144, s90
    v_perm_b32 v99, v156, v152, s90
    s_nop 1
    v_mfma_f32_16x16x32_bf16 v[64:67], v[96:99], v[32:35], 0
    v_perm_b32 v100, v132, v128, s91
    v_perm_b32 v101, v140, v136, s91
    v_perm_b32 v102, v148, v144, s91
    v_perm_b32 v103, v156, v152, s91
    s_nop 1
    v_mfma_f32_16x16x32_bf16 v[68:71], v[100:103], v[32:35], 0
    v_perm_b32 v104, v133, v129, s90
    v_perm_b32 v105, v141, v137, s90
    v_perm_b32 v106, v149, v145, s90
    v_perm_b32 v107, v157, v153, s90
    s_nop 1
    v_mfma_f32_16x16x32_bf16 v[72:75], v[104:107], v[32:35], 0
    v_perm_b32 v108, v133, v129, s91
    v_perm_b32 v109, v141, v137, s91
    v_perm_b32 v110, v149, v145, s91
    v_perm_b32 v111, v157, v153, s91
    s_nop 1
    v_mfma_f32_16x16x32_bf16 v[76:79], v[108:111], v[32:35], 0
    v_perm_b32 v96, v134, v130, s90
    v_perm_b32 v97, v142, v138, s90
    v_perm_b32 v98, v150, v146, s90
    v_perm_b32 v99, v158, v154, s90
    s_nop 1
    v_mfma_f32_16x16x32_bf16 v[80:83], v[96:99], v[32:35], 0
    v_perm_b32 v100, v134, v130, s91
    v_perm_b32 v101, v142, v138, s91
    v_perm_b32 v102, v150, v146, s91
    v_perm_b32 v103, v158, v154, s91
    s_nop 1
    v_mfma_f32_16x16x32_bf16 v[84:87], v[100:103], v[32:35], 0
    v_perm_b32 v104, v135, v131, s90
    v_perm_b32 v105, v143, v139, s90
    v_perm_b32 v106, v151, v147, s90
    v_perm_b32 v107, v159, v155, s90
    s_nop 1
    v_mfma_f32_16x16x32_bf16 v[88:91], v[104:107], v[32:35], 0
    v_perm_b32 v108, v135, v131, s91
    v_perm_b32 v109, v143, v139, s91
    v_perm_b32 v110, v151, v147, s91
    v_perm_b32 v111, v159, v155, s91
    s_nop 1
    v_mfma_f32_16x16x32_bf16 v[92:95], v[108:111], v[32:35], 0
    s_waitcnt vmcnt(8)
    buffer_load_dwordx4 v[128:131], v1, s[32:35], s25 offen offset:0 nt
    buffer_load_dwordx4 v[132:135], v1, s[32:35], s25 offen offset:256 nt
    s_waitcnt vmcnt(34)
    v_perm_b32 v96, v164, v160, s90
    v_perm_b32 v97, v172, v168, s90
    v_perm_b32 v98, v180, v176, s90
    v_perm_b32 v99, v188, v184, s90
    s_nop 1
    v_mfma_f32_16x16x32_bf16 v[64:67], v[96:99], v[36:39], v[64:67]
    v_perm_b32 v100, v164, v160, s91
    v_perm_b32 v101, v172, v168, s91
    v_perm_b32 v102, v180, v176, s91
    v_perm_b32 v103, v188, v184, s91
    s_nop 1
    v_mfma_f32_16x16x32_bf16 v[68:71], v[100:103], v[36:39], v[68:71]
    v_perm_b32 v104, v165, v161, s90
    v_perm_b32 v105, v173, v169, s90
    v_perm_b32 v106, v181, v177, s90
    v_perm_b32 v107, v189, v185, s90
    s_nop 1
    v_mfma_f32_16x16x32_bf16 v[72:75], v[104:107], v[36:39], v[72:75]
    v_perm_b32 v108, v165, v161, s91
    v_perm_b32 v109, v173, v169, s91
    v_perm_b32 v110, v181, v177, s91
    v_perm_b32 v111, v189, v185, s91
    s_nop 1
    v_mfma_f32_16x16x32_bf16 v[76:79], v[108:111], v[36:39], v[76:79]
    v_perm_b32 v96, v166, v162, s90
    v_perm_b32 v97, v174, v170, s90
    v_perm_b32 v98, v182, v178, s90
    v_perm_b32 v99, v190, v186, s90
    s_nop 1
    v_mfma_f32_16x16x32_bf16 v[80:83], v[96:99], v[36:39], v[80:83]
    v_perm_b32 v100, v166, v162, s91
    v_perm_b32 v101, v174, v170, s91
    v_perm_b32 v102, v182, v178, s91
    v_perm_b32 v103, v190, v186, s91
    s_nop 1
    s_waitcnt vmcnt(8)
    buffer_load_dwordx4 v[136:139], v1, s[32:35], s25 offen offset:512 nt
    buffer_load_dwordx4 v[140:143], v1, s[32:35], s25 offen offset:768 nt
    s_add_u32 s53, s53, 0x80000
    s_and_b32 s53, s53, 0x7fffff
    s_add_u32 s25, s51, s53
    v_mfma_f32_16x16x32_bf16 v[84:87], v[100:103], v[36:39], v[84:87]
    v_perm_b32 v104, v167, v163, s90
    v_perm_b32 v105, v175, v171, s90
    v_perm_b32 v106, v183, v179, s90
    v_perm_b32 v107, v191, v187, s90
    s_nop 1
    v_mfma_f32_16x16x32_bf16 v[88:91], v[104:107], v[36:39], v[88:91]
    v_perm_b32 v108, v167, v163, s91
    v_perm_b32 v109, v175, v171, s91
    v_perm_b32 v110, v183, v179, s91
    v_perm_b32 v111, v191, v187, s91
    s_nop 1
    v_mfma_f32_16x16x32_bf16 v[92:95], v[108:111], v[36:39], v[92:95]
    s_waitcnt vmcnt(28)
    v_perm_b32 v96, v196, v192, s90
    v_perm_b32 v97, v204, v200, s90
    v_perm_b32 v98, v212, v208, s90
    v_perm_b32 v99, v220, v216, s90
    s_nop 1
    v_mfma_f32_16x16x32_bf16 v[64:67], v[96:99], v[40:43], v[64:67]
    v_perm_b32 v100, v196, v192, s91
    v_perm_b32 v101, v204, v200, s91
    v_perm_b32 v102, v212, v208, s91
    v_perm_b32 v103, v220, v216, s91
    s_nop 1
    v_mfma_f32_16x16x32_bf16 v[68:71], v[100:103], v[40:43], v[68:71]
    v_perm_b32 v104, v197, v193, s90
    v_perm_b32 v105, v205, v201, s90
    v_perm_b32 v106, v213, v209, s90
    v_perm_b32 v107, v221, v217, s90
    s_nop 1
    v_mfma_f32_16x16x32_bf16 v[72:75], v[104:107], v[40:43], v[72:75]
    v_perm_b32 v108, v197, v193, s91
    v_perm_b32 v109, v205, v201, s91
    v_perm_b32 v110, v213, v209, s91
    v_perm_b32 v111, v221, v217, s91
    s_nop 1
    s_waitcnt vmcnt(8)
    buffer_load_dwordx4 v[144:147], v1, s[32:35], s25 offen offset:0 nt
    buffer_load_dwordx4 v[148:151], v1, s[32:35], s25 offen offset:256 nt
    v_mfma_f32_16x16x32_bf16 v[76:79], v[108:111], v[40:43], v[76:79]
    v_perm_b32 v96, v198, v194, s90
    v_perm_b32 v97, v206, v202, s90
    v_perm_b32 v98, v214, v210, s90
    v_perm_b32 v99, v222, v218, s90
    s_nop 1
    v_mfma_f32_16x16x32_bf16 v[80:83], v[96:99], v[40:43], v[80:83]
    v_perm_b32 v100, v198, v194, s91
    v_perm_b32 v101, v206, v202, s91
    v_perm_b32 v102, v214, v210, s91
    v_perm_b32 v103, v222, v218, s91
    s_nop 1
    v_mfma_f32_16x16x32_bf16 v[84:87], v[100:103], v[40:43], v[84:87]
    v_perm_b32 v104, v199, v195, s90
    v_perm_b32 v105, v207, v203, s90
    v_perm_b32 v106, v215, v211, s90
    v_perm_b32 v107, v223, v219, s90
    s_nop 1
    v_mfma_f32_16x16x32_bf16 v[88:91], v[104:107], v[40:43], v[88:91]
    v_perm_b32 v108, v199, v195, s91
    v_perm_b32 v109, v207, v203, s91
    v_perm_b32 v110, v215, v211, s91
    v_perm_b32 v111, v223, v219, s91
    s_nop 1
    v_mfma_f32_16x16x32_bf16 v[92:95], v[108:111], v[40:43], v[92:95]
    s_waitcnt vmcnt(22)
    v_perm_b32 v96, v228, v224, s90
    v_perm_b32 v97, v236, v232, s90
    v_perm_b32 v98, v244, v240, s90
    v_perm_b32 v99, v252, v248, s90
    s_nop 1
    v_mfma_f32_16x16x32_bf16 v[64:67], v[96:99], v[44:47], v[64:67]
    v_perm_b32 v100, v228, v224, s91
    v_perm_b32 v101, v236, v232, s91
    v_perm_b32 v102, v244, v240, s91
    v_perm_b32 v103, v252, v248, s91
    s_nop 1
    s_waitcnt vmcnt(8)
    buffer_load_dwordx4 v[152:155], v1, s[32:35], s25 offen offset:512 nt
    buffer_load_dwordx4 v[156:159], v1, s[32:35], s25 offen offset:768 nt
    s_add_u32 s53, s53, 0x80000
    s_and_b32 s53, s53, 0x7fffff
    s_add_u32 s25, s51, s53
    v_mfma_f32_16x16x32_bf16 v[68:71], v[100:103], v[44:47], v[68:71]
    v_perm_b32 v104, v229, v225, s90
    v_perm_b32 v105, v237, v233, s90
    v_perm_b32 v106, v245, v241, s90
    v_perm_b32 v107, v253, v249, s90
    s_nop 1
    v_mfma_f32_16x16x32_bf16 v[72:75], v[104:107], v[44:47], v[72:75]
    v_perm_b32 v108, v229, v225, s91
    v_perm_b32 v109, v237, v233, s91
    v_perm_b32 v110, v245, v241, s91
    v_perm_b32 v111, v253, v249, s91
    s_nop 1
    v_mfma_f32_16x16x32_bf16 v[76:79], v[108:111], v[44:47], v[76:79]
    v_perm_b32 v96, v230, v226, s90
    v_perm_b32 v97, v238, v234, s90
    v_perm_b32 v98, v246, v242, s90
    v_perm_b32 v99, v254, v250, s90
    s_nop 1
    v_mfma_f32_16x16x32_bf16 v[80:83], v[96:99], v[44:47], v[80:83]
    v_perm_b32 v100, v230, v226, s91
    v_perm_b32 v101, v238, v234, s91
    v_perm_b32 v102, v246, v242, s91
    v_perm_b32 v103, v254, v250, s91
    s_nop 1
    v_mfma_f32_16x16x32_bf16 v[84:87], v[100:103], v[44:47], v[84:87]
    v_perm_b32 v104, v231, v227, s90
    v_perm_b32 v105, v239, v235, s90
    v_perm_b32 v106, v247, v243, s90
    v_perm_b32 v107, v255, v251, s90
    s_nop 1
    v_mfma_f32_16x16x32_bf16 v[88:91], v[104:107], v[44:47], v[88:91]
    v_perm_b32 v108, v231, v227, s91
    v_perm_b32 v109, v239, v235, s91
    v_perm_b32 v110, v247, v243, s91
    v_perm_b32 v111, v255, v251, s91
    s_nop 1
    v_mfma_f32_16x16x32_bf16 v[92:95], v[108:111], v[44:47], v[92:95]
    v_mov_b32 v6, 133504
    v_mov_b32 v7, 2
    s_mov_b32 s59, 400000
    s_cmp_lg_u32 s23, 0
    s_cbranch_scc1 L_noreq0
    ds_write_b32 v6, v7
L_noreq0:
    s_waitcnt vmcnt(8)
    buffer_load_dwordx4 v[160:163], v1, s[32:35], s25 offen offset:0 nt
    buffer_load_dwordx4 v[164:167], v1, s[32:35], s25 offen offset:256 nt
    s_waitcnt vmcnt(18)
    ds_read_b128 v[96:99], v12 offset:0
    ds_read_b128 v[100:103], v13 offset:0
    ds_read_b128 v[104:107], v14 offset:0
    ds_read_b128 v[108:111], v15 offset:0
    ds_read_b128 v[112:115], v12 offset:4096
    ds_read_b128 v[116:119], v13 offset:4096
    ds_read_b128 v[120:123], v14 offset:4096
    ds_read_b128 v[124:127], v15 offset:4096
    s_waitcnt vmcnt(8)
    buffer_load_dwordx4 v[168:171], v1, s[32:35], s25 offen offset:512 nt
    buffer_load_dwordx4 v[172:175], v1, s[32:35], s25 offen offset:768 nt
    s_add_u32 s53, s53, 0x80000
    s_and_b32 s53, s53, 0x7fffff
    s_add_u32 s25, s51, s53
    s_waitcnt lgkmcnt(4)
    v_mfma_f32_16x16x32_bf16 v[32:35], v[96:99], v[16:19], 0
    v_mfma_f32_16x16x32_bf16 v[32:35], v[100:103], v[20:23], v[32:35]
    v_mfma_f32_16x16x32_bf16 v[32:35], v[104:107], v[24:27], v[32:35]
    v_mfma_f32_16x16x32_bf16 v[32:35], v[108:111], v[28:31], v[32:35]
    s_waitcnt lgkmcnt(0)
    v_mfma_f32_16x16x32_bf16 v[36:39], v[112:115], v[16:19], 0
    v_mfma_f32_16x16x32_bf16 v[36:39], v[116:119], v[20:23], v[36:39]
    v_mfma_f32_16x16x32_bf16 v[36:39], v[120:123], v[24:27], v[36:39]
    v_mfma_f32_16x16x32_bf16 v[36:39], v[124:127], v[28:31], v[36:39]
    s_waitcnt vmcnt(8)
    buffer_load_dwordx4 v[176:179], v1, s[32:35], s25 offen offset:0 nt
    buffer_load_dwordx4 v[180:183], v1, s[32:35], s25 offen offset:256 nt
    s_waitcnt vmcnt(14)
    ds_read_b128 v[96:99], v12 offset:8192
    ds_read_b128 v[100:103], v13 offset:8192
    ds_read_b128 v[104:107], v14 offset:8192
    ds_read_b128 v[108:111], v15 offset:8192
    ds_read_b128 v[112:115], v12 offset:12288
    ds_read_b128 v[116:119], v13 offset:12288
    ds_read_b128 v[120:123], v14 offset:12288
    ds_read_b128 v[124:127], v15 offset:12288
    s_waitcnt vmcnt(8)
    buffer_load_dwordx4 v[184:187], v1, s[32:35], s25 offen offset:512 nt
    buffer_load_dwordx4 v[188:191], v1, s[32:35], s25 offen offset:768 nt
    s_add_u32 s53, s53, 0x80000
    s_and_b32 s53, s53, 0x7fffff
    s_add_u32 s25, s51, s53
    s_waitcnt lgkmcnt(4)
    v_mfma_f32_16x16x32_bf16 v[40:43], v[96:99], v[16:19], 0
    v_mfma_f32_16x16x32_bf16 v[40:43], v[100:103], v[20:23], v[40:43]
    v_mfma_f32_16x16x32_bf16 v[40:43], v[104:107], v[24:27], v[40:43]
    v_mfma_f32_16x16x32_bf16 v[40:43], v[108:111], v[28:31], v[40:43]
    s_waitcnt lgkmcnt(0)
    v_mfma_f32_16x16x32_bf16 v[44:47], v[112:115], v[16:19], 0
    v_mfma_f32_16x16x32_bf16 v[44:47], v[116:119], v[20:23], v[44:47]
    v_mfma_f32_16x16x32_bf16 v[44:47], v[120:123], v[24:27], v[44:47]
    v_mfma_f32_16x16x32_bf16 v[44:47], v[124:127], v[28:31], v[44:47]
    v_mov_b32 v120, 133632
    v_mov_b32 v121, 133504
L_mba:
    ds_read_b32 v122, v120
    s_waitcnt lgkmcnt(0)
    v_readfirstlane_b32 s56, v122
    s_cmp_lg_u32 s56, -1
    s_cbranch_scc1 L_mba_ok
    s_sleep 1
    s_sub_u32 s59, s59, 1
    s_cmp_lg_u32 s59, 0
    s_cbranch_scc1 L_mba
L_mba_ok:
    v_add_u32 v120, 4, v120
    s_cmp_lt_u32 s56, 128
    s_cselect_b32 s57, 1, 0
    s_cselect_b32 s24, s23, 1
    s_cmp_lg_u32 s24, 0
    s_cbranch_scc1 L_mba_nr
    s_add_u32 s58, s58, 1
    v_mov_b32 v122, s58
    ds_write_b32 v121, v122
L_mba_nr:
    s_lshr_b32 s24, s56, 5
    s_add_u32 s24, s24, s55
    s_and_b32 s24, s24, 15
    s_lshl_b32 s24, s24, 19
    s_add_u32 s24, s24, s54
    s_and_b32 s25, s56, 31
    s_lshl_b32 s25, s25, 14
    s_add_u32 s24, s24, s25
    s_add_u32 m0, s50, 16384
    s_cmp_lg_u32 s57, 0
    s_cselect_b32 s24, s24, 0x7ff00000
    buffer_load_dwordx4 v8, s[28:31], s24 offen offset:0 nt lds
    buffer_load_dwordx4 v9, s[28:31], s24 offen offset:1024 nt lds
    buffer_load_dwordx4 v10, s[28:31], s24 offen offset:2048 nt lds
    buffer_load_dwordx4 v11, s[28:31], s24 offen offset:3072 nt lds
    buffer_load_dwordx4 v[192:195], v1, s[32:35], s24 offen offset:0 nt
    buffer_load_dwordx4 v[196:199], v1, s[32:35], s24 offen offset:256 nt
    buffer_load_dwordx4 v[200:203], v1, s[32:35], s24 offen offset:512 nt
    buffer_load_dwordx4 v[204:207], v1, s[32:35], s24 offen offset:768 nt
    s_nop 7
    v_max3_f32 v6, v32, v33, v34
    v_max3_f32 v7, v35, v36, v37
    v_max3_f32 v6, v6, v38, v39
    v_max3_f32 v7, v7, v40, v41
    v_max3_f32 v6, v6, v42, v43
    v_max3_f32 v7, v7, v44, v45
    v_max3_f32 v6, v6, v46, v47
    v_max_f32 v6, v6, v7
    s_nop 0
    v_mov_b32 v7, v6
    s_nop 1
    v_permlane32_swap_b32 v6, v7
    s_nop 1
    v_max_f32 v6, v6, v7
    s_nop 0
    v_mov_b32 v7, v6
    s_nop 1
    v_permlane16_swap_b32 v6, v7
    s_nop 1
    v_max_f32 v6, v6, v7
    v_mul_f32 v6, s42, v6
    v_max_f32 v6, v6, v2
    v_sub_f32 v7, v2, v6
    v_exp_f32 v7, v7
    v_mov_b32 v2, v6
    v_mul_f32 v5, v5, v7
    v_mul_f32 v64, v64, v7
    v_mul_f32 v65, v65, v7
    v_mul_f32 v66, v66, v7
    v_mul_f32 v67, v67, v7
    v_mul_f32 v68, v68, v7
    v_mul_f32 v69, v69, v7
    v_mul_f32 v70, v70, v7
    v_mul_f32 v71, v71, v7
    v_mul_f32 v72, v72, v7
    v_mul_f32 v73, v73, v7
    v_mul_f32 v74, v74, v7
    v_mul_f32 v75, v75, v7
    v_mul_f32 v76, v76, v7
    v_mul_f32 v77, v77, v7
    v_mul_f32 v78, v78, v7
    v_mul_f32 v79, v79, v7
    v_mul_f32 v80, v80, v7
    v_mul_f32 v81, v81, v7
    v_mul_f32 v82, v82, v7
    v_mul_f32 v83, v83, v7
    v_mul_f32 v84, v84, v7
    v_mul_f32 v85, v85, v7
    v_mul_f32 v86, v86, v7
    v_mul_f32 v87, v87, v7
    v_mul_f32 v88, v88, v7
    v_mul_f32 v89, v89, v7
    v_mul_f32 v90, v90, v7
    v_mul_f32 v91, v91, v7
    v_mul_f32 v92, v92, v7
    v_mul_f32 v93, v93, v7
    v_mul_f32 v94, v94, v7
    v_mul_f32 v95, v95, v7
    v_mov_b32 v6, 0
    v_fma_f32 v32, v32, s42, -v2
    v_fma_f32 v33, v33, s42, -v2
    v_fma_f32 v34, v34, s42, -v2
    v_fma_f32 v35, v35, s42, -v2
    v_fma_f32 v36, v36, s42, -v2
    v_fma_f32 v37, v37, s42, -v2
    v_fma_f32 v38, v38, s42, -v2
    v_fma_f32 v39, v39, s42, -v2
    v_fma_f32 v40, v40, s42, -v2
    v_fma_f32 v41, v41, s42, -v2
    v_fma_f32 v42, v42, s42, -v2
    v_fma_f32 v43, v43, s42, -v2
    v_fma_f32 v44, v44, s42, -v2
    v_fma_f32 v45, v45, s42, -v2
    v_fma_f32 v46, v46, s42, -v2
    v_fma_f32 v47, v47, s42, -v2
    v_exp_f32 v32, v32
    v_exp_f32 v33, v33
    v_exp_f32 v34, v34
    v_exp_f32 v35, v35
    v_exp_f32 v36, v36
    v_exp_f32 v37, v37
    v_exp_f32 v38, v38
    v_exp_f32 v39, v39
    v_exp_f32 v40, v40
    v_exp_f32 v41, v41
    v_exp_f32 v42, v42
    v_exp_f32 v43, v43
    v_exp_f32 v44, v44
    v_exp_f32 v45, v45
    v_exp_f32 v46, v46
    v_exp_f32 v47, v47
    s_nop 0
    v_add_f32 v5, v5, v32
    v_add_f32 v6, v6, v33
    v_cvt_pk_bf16_f32 v32, v32, v33
    v_add_f32 v5, v5, v34
    v_add_f32 v6, v6, v35
    v_cvt_pk_bf16_f32 v33, v34, v35
    v_add_f32 v5, v5, v36
    v_add_f32 v6, v6, v37
    v_cvt_pk_bf16_f32 v34, v36, v37
    v_add_f32 v5, v5, v38
    v_add_f32 v6, v6, v39
    v_cvt_pk_bf16_f32 v35, v38, v39
    v_add_f32 v5, v5, v40
    v_add_f32 v6, v6, v41
    v_cvt_pk_bf16_f32 v36, v40, v41
    v_add_f32 v5, v5, v42
    v_add_f32 v6, v6, v43
    v_cvt_pk_bf16_f32 v37, v42, v43
    v_add_f32 v5, v5, v44
    v_add_f32 v6, v6, v45
    v_cvt_pk_bf16_f32 v38, v44, v45
    v_add_f32 v5, v5, v46
    v_add_f32 v6, v6, v47
    v_cvt_pk_bf16_f32 v39, v46, v47
    v_add_f32 v5, v5, v6
    s_waitcnt vmcnt(16)
    v_perm_b32 v96, v132, v128, s90
    v_perm_b32 v97, v140, v136, s90
    v_perm_b32 v98, v148, v144, s90
    v_perm_b32 v99, v156, v152, s90
    s_nop 1
    v_mfma_f32_16x16x32_bf16 v[64:67], v[96:99], v[32:35], v[64:67]
    v_perm_b32 v100, v132, v128, s91
    v_perm_b32 v101, v140, v136, s91
    v_perm_b32 v102, v148, v144, s91
    v_perm_b32 v103, v156, v152, s91
    s_nop 1
    v_mfma_f32_16x16x32_bf16 v[68:71], v[100:103], v[32:35], v[68:71]
    v_perm_b32 v104, v133, v129, s90
    v_perm_b32 v105, v141, v137, s90
    v_perm_b32 v106, v149, v145, s90
    v_perm_b32 v107, v157, v153, s90
    s_nop 1
    v_mfma_f32_16x16x32_bf16 v[72:75], v[104:107], v[32:35], v[72:75]
    v_perm_b32 v108, v133, v129, s91
    v_perm_b32 v109, v141, v137, s91
    v_perm_b32 v110, v149, v145, s91
    v_perm_b32 v111, v157, v153, s91
    s_nop 1
    v_mfma_f32_16x16x32_bf16 v[76:79], v[108:111], v[32:35], v[76:79]
    v_perm_b32 v96, v134, v130, s90
    v_perm_b32 v97, v142, v138, s90
    v_perm_b32 v98, v150, v146, s90
    v_perm_b32 v99, v158, v154, s90
    s_nop 1
    v_mfma_f32_16x16x32_bf16 v[80:83], v[96:99], v[32:35], v[80:83]
    v_perm_b32 v100, v134, v130, s91
    v_perm_b32 v101, v142, v138, s91
    v_perm_b32 v102, v150, v146, s91
    v_perm_b32 v103, v158, v154, s91
    s_nop 1
    v_mfma_f32_16x16x32_bf16 v[84:87], v[100:103], v[32:35], v[84:87]
    v_perm_b32 v104, v135, v131, s90
    v_perm_b32 v105, v143, v139, s90
    v_perm_b32 v106, v151, v147, s90
    v_perm_b32 v107, v159, v155, s90
    s_nop 1
    v_mfma_f32_16x16x32_bf16 v[88:91], v[104:107], v[32:35], v[88:91]
    v_perm_b32 v108, v135, v131, s91
    v_perm_b32 v109, v143, v139, s91
    v_perm_b32 v110, v151, v147, s91
    v_perm_b32 v111, v159, v155, s91
    s_nop 1
    v_mfma_f32_16x16x32_bf16 v[92:95], v[108:111], v[32:35], v[92:95]
    s_waitcnt vmcnt(8)
    v_perm_b32 v96, v164, v160, s90
    v_perm_b32 v97, v172, v168, s90
    v_perm_b32 v98, v180, v176, s90
    v_perm_b32 v99, v188, v184, s90
    s_nop 1
    v_mfma_f32_16x16x32_bf16 v[64:67], v[96:99], v[36:39], v[64:67]
    v_perm_b32 v100, v164, v160, s91
    v_perm_b32 v101, v172, v168, s91
    v_perm_b32 v102, v180, v176, s91
    v_perm_b32 v103, v188, v184, s91
    s_nop 1
    v_mfma_f32_16x16x32_bf16 v[68:71], v[100:103], v[36:39], v[68:71]
    v_perm_b32 v104, v165, v161, s90
    v_perm_b32 v105, v173, v169, s90
    v_perm_b32 v106, v181, v177, s90
    v_perm_b32 v107, v189, v185, s90
    s_nop 1
    v_mfma_f32_16x16x32_bf16 v[72:75], v[104:107], v[36:39], v[72:75]
    v_perm_b32 v108, v165, v161, s91
    v_perm_b32 v109, v173, v169, s91
    v_perm_b32 v110, v181, v177, s91
    v_perm_b32 v111, v189, v185, s91
    s_nop 1
    v_mfma_f32_16x16x32_bf16 v[76:79], v[108:111], v[36:39], v[76:79]
    v_perm_b32 v96, v166, v162, s90
    v_perm_b32 v97, v174, v170, s90
    v_perm_b32 v98, v182, v178, s90
    v_perm_b32 v99, v190, v186, s90
    s_nop 1
    v_mfma_f32_16x16x32_bf16 v[80:83], v[96:99], v[36:39], v[80:83]
    v_perm_b32 v100, v166, v162, s91
    v_perm_b32 v101, v174, v170, s91
    v_perm_b32 v102, v182, v178, s91
    v_perm_b32 v103, v190, v186, s91
    s_nop 1
    v_mfma_f32_16x16x32_bf16 v[84:87], v[100:103], v[36:39], v[84:87]
    v_perm_b32 v104, v167, v163, s90
    v_perm_b32 v105, v175, v171, s90
    v_perm_b32 v106, v183, v179, s90
    v_perm_b32 v107, v191, v187, s90
    s_nop 1
    v_mfma_f32_16x16x32_bf16 v[88:91], v[104:107], v[36:39], v[88:91]
    v_perm_b32 v108, v167, v163, s91
    v_perm_b32 v109, v175, v171, s91
    v_perm_b32 v110, v183, v179, s91
    v_perm_b32 v111, v191, v187, s91
    s_nop 1
    v_mfma_f32_16x16x32_bf16 v[92:95], v[108:111], v[36:39], v[92:95]
    s_lshl_b32 s43, s23, 6
    v_lshlrev_b32 v53, 3, v3
    v_add_u32 v53, s43, v53
    v_add_u32 v53, 133120, v53
    v_mul_u32_u24 v48, 528, v3
    v_lshl_add_u32 v48, v4, 7, v48
    v_add_u32 v48, s50, v48
    s_lshl_b32 s43, s23, 1
    v_lshrrev_b32 v52, 5, v0
    v_add_u32 v52, s43, v52
    v_and_b32 v6, 31, v0
    v_lshlrev_b32 v49, 9, v52
    v_lshl_add_u32 v49, v6, 4, v49
    v_lshl_add_u32 v50, v52, 4, v49
    v_add_u32 v51, 65536, v50
    v_lshlrev_b32 v52, 3, v52
    v_add_u32 v52, 133120, v52
    s_lshl_b32 s43, s2, 12
    s_add_u32 s43, s43, 0x20000
    s_cmp_eq_u32 s57, 0
    s_cbranch_scc1 L_dyn_done
L_dyn_loop:
L_mbb:
    ds_read_b32 v122, v120
    s_waitcnt lgkmcnt(0)
    v_readfirstlane_b32 s56, v122
    s_cmp_lg_u32 s56, -1
    s_cbranch_scc1 L_mbb_ok
    s_sleep 1
    s_sub_u32 s59, s59, 1
    s_cmp_lg_u32 s59, 0
    s_cbranch_scc1 L_mbb
L_mbb_ok:
    v_add_u32 v120, 4, v120
    s_cmp_lt_u32 s56, 128
    s_cselect_b32 s57, 1, 0
    s_cselect_b32 s24, s23, 1
    s_cmp_lg_u32 s24, 0
    s_cbranch_scc1 L_mbb_nr
    s_add_u32 s58, s58, 1
    v_mov_b32 v122, s58
    ds_write_b32 v121, v122
L_mbb_nr:
    s_lshr_b32 s24, s56, 5
    s_add_u32 s24, s24, s55
    s_and_b32 s24, s24, 15
    s_lshl_b32 s24, s24, 19
    s_add_u32 s24, s24, s54
    s_and_b32 s25, s56, 31
    s_lshl_b32 s25, s25, 14
    s_add_u32 s24, s24, s25
    s_add_u32 m0, s50, 20480
    s_cmp_lg_u32 s57, 0
    s_cselect_b32 s24, s24, 0x7ff00000
    buffer_load_dwordx4 v8, s[28:31], s24 offen offset:0 nt lds
    buffer_load_dwordx4 v9, s[28:31], s24 offen offset:1024 nt lds
    buffer_load_dwordx4 v10, s[28:31], s24 offen offset:2048 nt lds
    buffer_load_dwordx4 v11, s[28:31], s24 offen offset:3072 nt lds
    buffer_load_dwordx4 v[208:211], v1, s[32:35], s24 offen offset:0 nt
    buffer_load_dwordx4 v[212:215], v1, s[32:35], s24 offen offset:256 nt
    buffer_load_dwordx4 v[216:219], v1, s[32:35], s24 offen offset:512 nt
    buffer_load_dwordx4 v[220:223], v1, s[32:35], s24 offen offset:768 nt
    s_waitcnt vmcnt(12)
    ds_read_b128 v[96:99], v12 offset:16384
    ds_read_b128 v[100:103], v13 offset:16384
    ds_read_b128 v[104:107], v14 offset:16384
    ds_read_b128 v[108:111], v15 offset:16384
    s_waitcnt lgkmcnt(3)
    v_mfma_f32_16x16x32_bf16 v[56:59], v[96:99], v[16:19], 0
    s_waitcnt lgkmcnt(2)
    v_mfma_f32_16x16x32_bf16 v[56:59], v[100:103], v[20:23], v[56:59]
    s_waitcnt lgkmcnt(1)
    v_mfma_f32_16x16x32_bf16 v[56:59], v[104:107], v[24:27], v[56:59]
    s_waitcnt lgkmcnt(0)
    v_mfma_f32_16x16x32_bf16 v[56:59], v[108:111], v[28:31], v[56:59]
    s_nop 7
    v_max3_f32 v6, v56, v57, v58
    v_max_f32 v6, v6, v59
    s_nop 0
    v_mov_b32 v7, v6
    s_nop 1
    v_permlane32_swap_b32 v6, v7
    s_nop 1
    v_max_f32 v6, v6, v7
    s_nop 0
    v_mov_b32 v7, v6
    s_nop 1
    v_permlane16_swap_b32 v6, v7
    s_nop 1
    v_max_f32 v6, v6, v7
    v_mul_f32 v6, s42, v6
    v_cmp_gt_f32 vcc, v6, v2
    s_cbranch_vccz L_norsb
    v_max_f32 v6, v6, v2
    v_sub_f32 v7, v2, v6
    v_exp_f32 v7, v7
    v_mov_b32 v2, v6
    v_mul_f32 v5, v5, v7
    v_mul_f32 v64, v64, v7
    v_mul_f32 v65, v65, v7
    v_mul_f32 v66, v66, v7
    v_mul_f32 v67, v67, v7
    v_mul_f32 v68, v68, v7
    v_mul_f32 v69, v69, v7
    v_mul_f32 v70, v70, v7
    v_mul_f32 v71, v71, v7
    v_mul_f32 v72, v72, v7
    v_mul_f32 v73, v73, v7
    v_mul_f32 v74, v74, v7
    v_mul_f32 v75, v75, v7
    v_mul_f32 v76, v76, v7
    v_mul_f32 v77, v77, v7
    v_mul_f32 v78, v78, v7
    v_mul_f32 v79, v79, v7
    v_mul_f32 v80, v80, v7
    v_mul_f32 v81, v81, v7
    v_mul_f32 v82, v82, v7
    v_mul_f32 v83, v83, v7
    v_mul_f32 v84, v84, v7
    v_mul_f32 v85, v85, v7
    v_mul_f32 v86, v86, v7
    v_mul_f32 v87, v87, v7
    v_mul_f32 v88, v88, v7
    v_mul_f32 v89, v89, v7
    v_mul_f32 v90, v90, v7
    v_mul_f32 v91, v91, v7
    v_mul_f32 v92, v92, v7
    v_mul_f32 v93, v93, v7
    v_mul_f32 v94, v94, v7
    v_mul_f32 v95, v95, v7
L_norsb:
    v_fma_f32 v56, v56, s42, -v2
    v_fma_f32 v57, v57, s42, -v2
    v_fma_f32 v58, v58, s42, -v2
    v_fma_f32 v59, v59, s42, -v2
    v_exp_f32 v56, v56
    v_exp_f32 v57, v57
    v_exp_f32 v58, v58
    v_exp_f32 v59, v59
    s_waitcnt vmcnt(8)
    v_add_f32 v6, v56, v57
    v_add_f32 v7, v58, v59
    v_cvt_pk_bf16_f32 v60, v56, v57
    v_cvt_pk_bf16_f32 v61, v58, v59
    v_add_f32 v5, v5, v6
    v_add_f32 v5, v5, v7
    v_perm_b32 v112, v196, v192, s90
    v_perm_b32 v113, v204, v200, s90
    s_nop 1
    v_mfma_f32_16x16x16_bf16 v[64:67], v[112:113], v[60:61], v[64:67]
    v_perm_b32 v114, v196, v192, s91
    v_perm_b32 v115, v204, v200, s91
    s_nop 1
    v_mfma_f32_16x16x16_bf16 v[68:71], v[114:115], v[60:61], v[68:71]
    v_perm_b32 v116, v197, v193, s90
    v_perm_b32 v117, v205, v201, s90
    s_nop 1
    v_mfma_f32_16x16x16_bf16 v[72:75], v[116:117], v[60:61], v[72:75]
    v_perm_b32 v118, v197, v193, s91
    v_perm_b32 v119, v205, v201, s91
    s_nop 1
    v_mfma_f32_16x16x16_bf16 v[76:79], v[118:119], v[60:61], v[76:79]
    v_perm_b32 v112, v198, v194, s90
    v_perm_b32 v113, v206, v202, s90
    s_nop 1
    v_mfma_f32_16x16x16_bf16 v[80:83], v[112:113], v[60:61], v[80:83]
    v_perm_b32 v114, v198, v194, s91
    v_perm_b32 v115, v206, v202, s91
    s_nop 1
    v_mfma_f32_16x16x16_bf16 v[84:87], v[114:115], v[60:61], v[84:87]
    v_perm_b32 v116, v199, v195, s90
    v_perm_b32 v117, v207, v203, s90
    s_nop 1
    v_mfma_f32_16x16x16_bf16 v[88:91], v[116:117], v[60:61], v[88:91]
    v_perm_b32 v118, v199, v195, s91
    v_perm_b32 v119, v207, v203, s91
    s_nop 1
    v_mfma_f32_16x16x16_bf16 v[92:95], v[118:119], v[60:61], v[92:95]
    s_cmp_eq_u32 s57, 0
    s_cbranch_scc1 L_dyn_done
L_mbc:
    ds_read_b32 v122, v120
    s_waitcnt lgkmcnt(0)
    v_readfirstlane_b32 s56, v122
    s_cmp_lg_u32 s56, -1
    s_cbranch_scc1 L_mbc_ok
    s_sleep 1
    s_sub_u32 s59, s59, 1
    s_cmp_lg_u32 s59, 0
    s_cbranch_scc1 L_mbc
L_mbc_ok:
    v_add_u32 v120, 4, v120
    s_cmp_lt_u32 s56, 128
    s_cselect_b32 s57, 1, 0
    s_cselect_b32 s24, s23, 1
    s_cmp_lg_u32 s24, 0
    s_cbranch_scc1 L_mbc_nr
    s_add_u32 s58, s58, 1
    v_mov_b32 v122, s58
    ds_write_b32 v121, v122
L_mbc_nr:
    s_lshr_b32 s24, s56, 5
    s_add_u32 s24, s24, s55
    s_and_b32 s24, s24, 15
    s_lshl_b32 s24, s24, 19
    s_add_u32 s24, s24, s54
    s_and_b32 s25, s56, 31
    s_lshl_b32 s25, s25, 14
    s_add_u32 s24, s24, s25
    s_add_u32 m0, s50, 16384
    s_cmp_lg_u32 s57, 0
    s_cselect_b32 s24, s24, 0x7ff00000
    buffer_load_dwordx4 v8, s[28:31], s24 offen offset:0 nt lds
    buffer_load_dwordx4 v9, s[28:31], s24 offen offset:1024 nt lds
    buffer_load_dwordx4 v10, s[28:31], s24 offen offset:2048 nt lds
    buffer_load_dwordx4 v11, s[28:31], s24 offen offset:3072 nt lds
    buffer_load_dwordx4 v[192:195], v1, s[32:35], s24 offen offset:0 nt
    buffer_load_dwordx4 v[196:199], v1, s[32:35], s24 offen offset:256 nt
    buffer_load_dwordx4 v[200:203], v1, s[32:35], s24 offen offset:512 nt
    buffer_load_dwordx4 v[204:207], v1, s[32:35], s24 offen offset:768 nt
    s_waitcnt vmcnt(12)
    ds_read_b128 v[96:99], v12 offset:20480
    ds_read_b128 v[100:103], v13 offset:20480
    ds_read_b128 v[104:107], v14 offset:20480
    ds_read_b128 v[108:111], v15 offset:20480
    s_waitcnt lgkmcnt(3)
    v_mfma_f32_16x16x32_bf16 v[56:59], v[96:99], v[16:19], 0
    s_waitcnt lgkmcnt(2)
    v_mfma_f32_16x16x32_bf16 v[56:59], v[100:103], v[20:23], v[56:59]
    s_waitcnt lgkmcnt(1)
    v_mfma_f32_16x16x32_bf16 v[56:59], v[104:107], v[24:27], v[56:59]
    s_waitcnt lgkmcnt(0)
    v_mfma_f32_16x16x32_bf16 v[56:59], v[108:111], v[28:31], v[56:59]
    s_nop 7
    v_max3_f32 v6, v56, v57, v58
    v_max_f32 v6, v6, v59
    s_nop 0
    v_mov_b32 v7, v6
    s_nop 1
    v_permlane32_swap_b32 v6, v7
    s_nop 1
    v_max_f32 v6, v6, v7
    s_nop 0
    v_mov_b32 v7, v6
    s_nop 1
    v_permlane16_swap_b32 v6, v7
    s_nop 1
    v_max_f32 v6, v6, v7
    v_mul_f32 v6, s42, v6
    v_cmp_gt_f32 vcc, v6, v2
    s_cbranch_vccz L_norsc
    v_max_f32 v6, v6, v2
    v_sub_f32 v7, v2, v6
    v_exp_f32 v7, v7
    v_mov_b32 v2, v6
    v_mul_f32 v5, v5, v7
    v_mul_f32 v64, v64, v7
    v_mul_f32 v65, v65, v7
    v_mul_f32 v66, v66, v7
    v_mul_f32 v67, v67, v7
    v_mul_f32 v68, v68, v7
    v_mul_f32 v69, v69, v7
    v_mul_f32 v70, v70, v7
    v_mul_f32 v71, v71, v7
    v_mul_f32 v72, v72, v7
    v_mul_f32 v73, v73, v7
    v_mul_f32 v74, v74, v7
    v_mul_f32 v75, v75, v7
    v_mul_f32 v76, v76, v7
    v_mul_f32 v77, v77, v7
    v_mul_f32 v78, v78, v7
    v_mul_f32 v79, v79, v7
    v_mul_f32 v80, v80, v7
    v_mul_f32 v81, v81, v7
    v_mul_f32 v82, v82, v7
    v_mul_f32 v83, v83, v7
    v_mul_f32 v84, v84, v7
    v_mul_f32 v85, v85, v7
    v_mul_f32 v86, v86, v7
    v_mul_f32 v87, v87, v7
    v_mul_f32 v88, v88, v7
    v_mul_f32 v89, v89, v7
    v_mul_f32 v90, v90, v7
    v_mul_f32 v91, v91, v7
    v_mul_f32 v92, v92, v7
    v_mul_f32 v93, v93, v7
    v_mul_f32 v94, v94, v7
    v_mul_f32 v95, v95, v7
L_norsc:
    v_fma_f32 v56, v56, s42, -v2
    v_fma_f32 v57, v57, s42, -v2
    v_fma_f32 v58, v58, s42, -v2
    v_fma_f32 v59, v59, s42, -v2
    v_exp_f32 v56, v56
    v_exp_f32 v57, v57
    v_exp_f32 v58, v58
    v_exp_f32 v59, v59
    s_waitcnt vmcnt(8)
    v_add_f32 v6, v56, v57
    v_add_f32 v7, v58, v59
    v_cvt_pk_bf16_f32 v60, v56, v57
    v_cvt_pk_bf16_f32 v61, v58, v59
    v_add_f32 v5, v5, v6
    v_add_f32 v5, v5, v7
    v_perm_b32 v112, v212, v208, s90
    v_perm_b32 v113, v220, v216, s90
    s_nop 1
    v_mfma_f32_16x16x16_bf16 v[64:67], v[112:113], v[60:61], v[64:67]
    v_perm_b32 v114, v212, v208, s91
    v_perm_b32 v115, v220, v216, s91
    s_nop 1
    v_mfma_f32_16x16x16_bf16 v[68:71], v[114:115], v[60:61], v[68:71]
    v_perm_b32 v116, v213, v209, s90
    v_perm_b32 v117, v221, v217, s90
    s_nop 1
    v_mfma_f32_16x16x16_bf16 v[72:75], v[116:117], v[60:61], v[72:75]
    v_perm_b32 v118, v213, v209, s91
    v_perm_b32 v119, v221, v217, s91
    s_nop 1
    v_mfma_f32_16x16x16_bf16 v[76:79], v[118:119], v[60:61], v[76:79]
    v_perm_b32 v112, v214, v210, s90
    v_perm_b32 v113, v222, v218, s90
    s_nop 1
    v_mfma_f32_16x16x16_bf16 v[80:83], v[112:113], v[60:61], v[80:83]
    v_perm_b32 v114, v214, v210, s91
    v_perm_b32 v115, v222, v218, s91
    s_nop 1
    v_mfma_f32_16x16x16_bf16 v[84:87], v[114:115], v[60:61], v[84:87]
    v_perm_b32 v116, v215, v211, s90
    v_perm_b32 v117, v223, v219, s90
    s_nop 1
    v_mfma_f32_16x16x16_bf16 v[88:91], v[116:117], v[60:61], v[88:91]
    v_perm_b32 v118, v215, v211, s91
    v_perm_b32 v119, v223, v219, s91
    s_nop 1
    v_mfma_f32_16x16x16_bf16 v[92:95], v[118:119], v[60:61], v[92:95]
    s_cmp_lg_u32 s57, 0
    s_cbranch_scc1 L_dyn_loop
L_dyn_done:
    s_nop 6
    s_mov_b64 exec, s[40:41]
    ds_write_b128 v48, v[64:67] offset:0
    ds_write_b128 v48, v[68:71] offset:16
    ds_write_b128 v48, v[72:75] offset:32
    ds_write_b128 v48, v[76:79] offset:48
    ds_write_b128 v48, v[80:83] offset:64
    ds_write_b128 v48, v[84:87] offset:80
    ds_write_b128 v48, v[88:91] offset:96
    ds_write_b128 v48, v[92:95] offset:112
    s_mov_b64 exec, -1
    v_mov_b32 v6, v5
    s_nop 1
    v_permlane32_swap_b32 v5, v6
    s_nop 1
    v_add_f32 v5, v5, v6
    s_nop 0
    v_mov_b32 v6, v5
    s_nop 1
    v_permlane16_swap_b32 v5, v6
    s_nop 1
    v_add_f32 v5, v5, v6
    v_mov_b32 v4, v2
    s_mov_b64 exec, 0xff
    ds_write_b64 v53, v[4:5]
    s_mov_b64 exec, -1
    v_mov_b32 v8, v49
    s_waitcnt lgkmcnt(0)
    s_barrier
    ds_read_b64 v[40:41], v52 offset:0
    ds_read_b64 v[42:43], v52 offset:64
    ds_read_b64 v[44:45], v52 offset:128
    ds_read_b64 v[46:47], v52 offset:192
    ds_read_b128 v[16:19], v50 offset:0
    ds_read_b128 v[20:23], v50 offset:32768
    ds_read_b128 v[24:27], v51 offset:0
    ds_read_b128 v[28:31], v51 offset:32768
    s_waitcnt lgkmcnt(4)
    v_max_f32 v32, v40, v42
    v_max3_f32 v32, v32, v44, v46
    v_sub_f32 v40, v40, v32
    v_sub_f32 v42, v42, v32
    v_sub_f32 v44, v44, v32
    v_sub_f32 v46, v46, v32
    v_exp_f32 v40, v40
    v_exp_f32 v42, v42
    v_exp_f32 v44, v44
    v_exp_f32 v46, v46
    s_waitcnt lgkmcnt(0)
    v_mul_f32 v36, v40, v16
    v_mul_f32 v37, v40, v17
    v_mul_f32 v38, v40, v18
    v_mul_f32 v39, v40, v19
    v_fmac_f32 v36, v42, v20
    v_fmac_f32 v37, v42, v21
    v_fmac_f32 v38, v42, v22
    v_fmac_f32 v39, v42, v23
    v_fmac_f32 v36, v44, v24
    v_fmac_f32 v37, v44, v25
    v_fmac_f32 v38, v44, v26
    v_fmac_f32 v39, v44, v27
    v_fmac_f32 v36, v46, v28
    v_fmac_f32 v37, v46, v29
    v_fmac_f32 v38, v46, v30
    v_fmac_f32 v39, v46, v31
    v_min_u32 v36, -2, v36
    v_min_u32 v37, -2, v37
    v_min_u32 v38, -2, v38
    v_min_u32 v39, -2, v39
    buffer_store_dwordx4 v[36:39], v8, s[36:39], s43 offen sc1
    s_barrier
    s_endpgm
L_helper:
    s_setprio 3
    s_sub_u32 s23, s23, 4
    s_and_b32 s46, s2, 1
    s_bfe_u32 s47, s2, 0x50001
    s_lshl_b32 s48, s20, 5
    s_add_u32 s48, s48, s47
    s_waitcnt lgkmcnt(0)
    s_mov_b32 s36, s18
    s_and_b32 s37, s19, 0xffff
    s_mov_b32 s38, 0x24c000
    s_mov_b32 s39, 0x20000
    s_and_b32 s21, s2, 15
    s_bfe_u32 s22, s2, 0x20004
    v_lshlrev_b32 v1, 4, v0
    s_lshl_b32 s52, s22, 15
    s_lshl_b32 s25, s20, 12
    s_add_u32 s52, s52, s25
    s_lshl_b32 s25, s21, 8
    s_add_u32 s52, s52, s25
    s_add_u32 s53, s52, 16384
    s_cmp_eq_u32 s23, 0
    s_cbranch_scc1 L_h0
    s_cmp_eq_u32 s23, 1
    s_cbranch_scc1 L_h1
    s_barrier
    s_branch L_h_notq
L_h1:
    v_mov_b32 v6, 0
    v_mov_b32 v7, 135168
    ds_write_b32 v7, v6
    ds_write_b32 v7, v6 offset:4
    v_mov_b32 v9, 133504
    ds_write_b32 v9, v6
    v_mov_b32 v8, -1
    v_lshlrev_b32 v9, 2, v0
    v_add_u32 v9, 133632, v9
    ds_write_b32 v9, v8
    ds_write_b32 v9, v8 offset:256
    ds_write_b32 v9, v8 offset:512
    ds_write_b32 v9, v8 offset:768
    v_mov_b32 v9, -1
    v_mov_b32 v10, -1
    v_mov_b32 v11, -1
    s_lshl_b32 s43, s2, 12
    s_add_u32 s43, s43, 0x20000
    s_lshl_b32 s44, s2, 6
    s_add_u32 s44, s44, 0x120000
    s_lshl_b32 s24, s48, 13
    s_lshl_b32 s25, s46, 11
    s_add_u32 s24, s24, s25
    s_add_u32 s24, s24, 0x124000
    s_add_u32 s25, s24, 4096
    s_mov_b64 exec, 0xffff
    buffer_store_dwordx4 v[8:11], v1, s[36:39], s52 offen sc1
    buffer_store_dwordx4 v[8:11], v1, s[36:39], s53 offen sc1
    s_mov_b64 exec, 0xf
    buffer_store_dwordx4 v[8:11], v1, s[36:39], s44 offen sc1
    s_mov_b64 exec, -1
    buffer_store_dwordx4 v[8:11], v1, s[36:39], s43 offen offset:0 sc1
    buffer_store_dwordx4 v[8:11], v1, s[36:39], s43 offen offset:1024 sc1
    buffer_store_dwordx4 v[8:11], v1, s[36:39], s43 offen offset:2048 sc1
    buffer_store_dwordx4 v[8:11], v1, s[36:39], s43 offen offset:3072 sc1
    buffer_store_dwordx4 v[8:11], v1, s[36:39], s24 offen offset:0 sc1
    buffer_store_dwordx4 v[8:11], v1, s[36:39], s24 offen offset:1024 sc1
    buffer_store_dwordx4 v[8:11], v1, s[36:39], s25 offen offset:0 sc1
    buffer_store_dwordx4 v[8:11], v1, s[36:39], s25 offen offset:1024 sc1
    s_and_b32 s24, s2, 31
    s_cmp_lg_u32 s24, 0
    s_cbranch_scc1 L_h1_notk
    s_lshr_b32 s24, s2, 5
    s_lshl_b32 s24, s24, 12
    s_add_u32 s24, s24, 0x244000
    v_mov_b32 v12, 0
    v_mov_b32 v13, 0
    v_mov_b32 v14, 0
    v_mov_b32 v15, 0
    s_mov_b64 exec, 0xff
    buffer_store_dwordx4 v[12:15], v1, s[36:39], s24 offen sc1
    s_mov_b64 exec, -1
L_h1_notk:
    s_lshl_b32 s26, s20, 6
    v_mov_b32 v2, s26
    v_mov_b32 v5, 1
    v_mov_b32 v6, 2
    v_and_b32 v12, 3, v0
    v_lshlrev_b32 v12, 6, v12
    s_mov_b32 s60, 400000
    s_waitcnt lgkmcnt(0)
    s_barrier
    s_waitcnt vmcnt(0)
    s_mov_b64 exec, 1
    global_atomic_add v2, v5, s[16:17] sc1
    ds_write_b32 v7, v5
    s_mov_b64 exec, 0xf
    s_mov_b64 exec, -1
    s_branch L_h_notq
L_h0:
    s_mov_b32 s28, s10
    s_and_b32 s29, s11, 0xffff
    s_mov_b32 s30, 0x800000
    s_mov_b32 s31, 0x20000
    s_mov_b32 s32, s4
    s_and_b32 s33, s5, 0xffff
    s_mov_b32 s34, 0x1000
    s_mov_b32 s35, 0x20000
    v_and_b32 v9, 7, v3
    v_lshrrev_b32 v10, 3, v3
    v_lshlrev_b32 v5, 18, v10
    v_lshlrev_b32 v6, 16, v4
    v_lshlrev_b32 v7, 4, v9
    v_add3_u32 v5, v5, v6, v7
    v_and_b32 v6, 1, v0
    v_lshlrev_b32 v6, 11, v6
    v_bfe_u32 v7, v0, 1, 1
    v_lshlrev_b32 v7, 6, v7
    v_lshlrev_b32 v8, 4, v4
    v_add3_u32 v6, v6, v7, v8
    s_lshl_b32 s24, s22, 21
    s_lshl_b32 s25, s20, 11
    s_add_u32 s24, s24, s25
    s_lshl_b32 s25, s21, 7
    s_add_u32 s24, s24, s25
    s_lshl_b32 s26, s22, 9
    buffer_load_dwordx4 v[16:19], v6, s[32:35], s26 offen offset:0
    buffer_load_dwordx4 v[20:23], v6, s[32:35], s26 offen offset:128
    buffer_load_dwordx4 v[24:27], v6, s[32:35], s26 offen offset:256
    buffer_load_dwordx4 v[28:31], v6, s[32:35], s26 offen offset:384
    buffer_load_dwordx4 v[64:67], v5, s[28:31], s24 offen nt
    s_add_u32 s24, s24, 8192
    buffer_load_dwordx4 v[68:71], v5, s[28:31], s24 offen nt
    s_add_u32 s24, s24, 8192
    buffer_load_dwordx4 v[72:75], v5, s[28:31], s24 offen nt
    s_add_u32 s24, s24, 8192
    buffer_load_dwordx4 v[76:79], v5, s[28:31], s24 offen nt
    s_add_u32 s24, s24, 8192
    buffer_load_dwordx4 v[80:83], v5, s[28:31], s24 offen nt
    s_add_u32 s24, s24, 8192
    buffer_load_dwordx4 v[84:87], v5, s[28:31], s24 offen nt
    s_add_u32 s24, s24, 8192
    buffer_load_dwordx4 v[88:91], v5, s[28:31], s24 offen nt
    s_add_u32 s24, s24, 8192
    buffer_load_dwordx4 v[92:95], v5, s[28:31], s24 offen nt
    s_add_u32 s24, s24, 466944
    buffer_load_dwordx4 v[96:99], v5, s[28:31], s24 offen nt
    s_add_u32 s24, s24, 8192
    buffer_load_dwordx4 v[100:103], v5, s[28:31], s24 offen nt
    s_add_u32 s24, s24, 8192
    buffer_load_dwordx4 v[104:107], v5, s[28:31], s24 offen nt
    s_add_u32 s24, s24, 8192
    buffer_load_dwordx4 v[108:111], v5, s[28:31], s24 offen nt
    s_add_u32 s24, s24, 8192
    buffer_load_dwordx4 v[112:115], v5, s[28:31], s24 offen nt
    s_add_u32 s24, s24, 8192
    buffer_load_dwordx4 v[116:119], v5, s[28:31], s24 offen nt
    s_add_u32 s24, s24, 8192
    buffer_load_dwordx4 v[120:123], v5, s[28:31], s24 offen nt
    s_add_u32 s24, s24, 8192
    buffer_load_dwordx4 v[124:127], v5, s[28:31], s24 offen nt
    s_add_u32 s24, s24, 466944
    buffer_load_dwordx4 v[128:131], v5, s[28:31], s24 offen nt
    s_add_u32 s24, s24, 8192
    buffer_load_dwordx4 v[132:135], v5, s[28:31], s24 offen nt
    s_add_u32 s24, s24, 8192
    buffer_load_dwordx4 v[136:139], v5, s[28:31], s24 offen nt
    s_add_u32 s24, s24, 8192
    buffer_load_dwordx4 v[140:143], v5, s[28:31], s24 offen nt
    s_add_u32 s24, s24, 8192
    buffer_load_dwordx4 v[144:147], v5, s[28:31], s24 offen nt
    s_add_u32 s24, s24, 8192
    buffer_load_dwordx4 v[148:151], v5, s[28:31], s24 offen nt
    s_add_u32 s24, s24, 8192
    buffer_load_dwordx4 v[152:155], v5, s[28:31], s24 offen nt
    s_add_u32 s24, s24, 8192
    buffer_load_dwordx4 v[156:159], v5, s[28:31], s24 offen nt
    s_add_u32 s24, s24, 466944
    buffer_load_dwordx4 v[160:163], v5, s[28:31], s24 offen nt
    s_add_u32 s24, s24, 8192
    buffer_load_dwordx4 v[164:167], v5, s[28:31], s24 offen nt
    s_add_u32 s24, s24, 8192
    buffer_load_dwordx4 v[168:171], v5, s[28:31], s24 offen nt
    s_add_u32 s24, s24, 8192
    buffer_load_dwordx4 v[172:175], v5, s[28:31], s24 offen nt
    s_add_u32 s24, s24, 8192
    buffer_load_dwordx4 v[176:179], v5, s[28:31], s24 offen nt
    s_add_u32 s24, s24, 8192
    buffer_load_dwordx4 v[180:183], v5, s[28:31], s24 offen nt
    s_add_u32 s24, s24, 8192
    buffer_load_dwordx4 v[184:187], v5, s[28:31], s24 offen nt
    s_add_u32 s24, s24, 8192
    buffer_load_dwordx4 v[188:191], v5, s[28:31], s24 offen nt
    s_add_u32 s24, s24, 466944
    s_barrier
    s_waitcnt vmcnt(24)
    v_perm_b32 v192, v68, v64, s90
    v_perm_b32 v193, v76, v72, s90
    v_perm_b32 v194, v84, v80, s90
    v_perm_b32 v195, v92, v88, s90
    s_nop 1
    v_mfma_f32_16x16x32_bf16 v[32:35], v[16:19], v[192:195], 0
    v_perm_b32 v196, v68, v64, s91
    v_perm_b32 v197, v76, v72, s91
    v_perm_b32 v198, v84, v80, s91
    v_perm_b32 v199, v92, v88, s91
    s_nop 1
    v_mfma_f32_16x16x32_bf16 v[36:39], v[16:19], v[196:199], 0
    v_perm_b32 v200, v69, v65, s90
    v_perm_b32 v201, v77, v73, s90
    v_perm_b32 v202, v85, v81, s90
    v_perm_b32 v203, v93, v89, s90
    s_nop 1
    v_mfma_f32_16x16x32_bf16 v[40:43], v[16:19], v[200:203], 0
    v_perm_b32 v204, v69, v65, s91
    v_perm_b32 v205, v77, v73, s91
    v_perm_b32 v206, v85, v81, s91
    v_perm_b32 v207, v93, v89, s91
    s_nop 1
    v_mfma_f32_16x16x32_bf16 v[44:47], v[16:19], v[204:207], 0
    v_perm_b32 v192, v70, v66, s90
    v_perm_b32 v193, v78, v74, s90
    v_perm_b32 v194, v86, v82, s90
    v_perm_b32 v195, v94, v90, s90
    s_nop 1
    v_mfma_f32_16x16x32_bf16 v[48:51], v[16:19], v[192:195], 0
    v_perm_b32 v196, v70, v66, s91
    v_perm_b32 v197, v78, v74, s91
    v_perm_b32 v198, v86, v82, s91
    v_perm_b32 v199, v94, v90, s91
    s_nop 1
    v_mfma_f32_16x16x32_bf16 v[52:55], v[16:19], v[196:199], 0
    v_perm_b32 v200, v71, v67, s90
    v_perm_b32 v201, v79, v75, s90
    v_perm_b32 v202, v87, v83, s90
    v_perm_b32 v203, v95, v91, s90
    s_nop 1
    v_mfma_f32_16x16x32_bf16 v[56:59], v[16:19], v[200:203], 0
    v_perm_b32 v204, v71, v67, s91
    v_perm_b32 v205, v79, v75, s91
    v_perm_b32 v206, v87, v83, s91
    v_perm_b32 v207, v95, v91, s91
    s_nop 1
    v_mfma_f32_16x16x32_bf16 v[60:63], v[16:19], v[204:207], 0
    s_waitcnt vmcnt(16)
    v_perm_b32 v192, v100, v96, s90
    v_perm_b32 v193, v108, v104, s90
    v_perm_b32 v194, v116, v112, s90
    v_perm_b32 v195, v124, v120, s90
    s_nop 1
    v_mfma_f32_16x16x32_bf16 v[32:35], v[20:23], v[192:195], v[32:35]
    v_perm_b32 v196, v100, v96, s91
    v_perm_b32 v197, v108, v104, s91
    v_perm_b32 v198, v116, v112, s91
    v_perm_b32 v199, v124, v120, s91
    s_nop 1
    v_mfma_f32_16x16x32_bf16 v[36:39], v[20:23], v[196:199], v[36:39]
    v_perm_b32 v200, v101, v97, s90
    v_perm_b32 v201, v109, v105, s90
    v_perm_b32 v202, v117, v113, s90
    v_perm_b32 v203, v125, v121, s90
    s_nop 1
    v_mfma_f32_16x16x32_bf16 v[40:43], v[20:23], v[200:203], v[40:43]
    v_perm_b32 v204, v101, v97, s91
    v_perm_b32 v205, v109, v105, s91
    v_perm_b32 v206, v117, v113, s91
    v_perm_b32 v207, v125, v121, s91
    s_nop 1
    v_mfma_f32_16x16x32_bf16 v[44:47], v[20:23], v[204:207], v[44:47]
    v_perm_b32 v192, v102, v98, s90
    v_perm_b32 v193, v110, v106, s90
    v_perm_b32 v194, v118, v114, s90
    v_perm_b32 v195, v126, v122, s90
    s_nop 1
    v_mfma_f32_16x16x32_bf16 v[48:51], v[20:23], v[192:195], v[48:51]
    v_perm_b32 v196, v102, v98, s91
    v_perm_b32 v197, v110, v106, s91
    v_perm_b32 v198, v118, v114, s91
    v_perm_b32 v199, v126, v122, s91
    s_nop 1
    v_mfma_f32_16x16x32_bf16 v[52:55], v[20:23], v[196:199], v[52:55]
    v_perm_b32 v200, v103, v99, s90
    v_perm_b32 v201, v111, v107, s90
    v_perm_b32 v202, v119, v115, s90
    v_perm_b32 v203, v127, v123, s90
    s_nop 1
    v_mfma_f32_16x16x32_bf16 v[56:59], v[20:23], v[200:203], v[56:59]
    v_perm_b32 v204, v103, v99, s91
    v_perm_b32 v205, v111, v107, s91
    v_perm_b32 v206, v119, v115, s91
    v_perm_b32 v207, v127, v123, s91
    s_nop 1
    v_mfma_f32_16x16x32_bf16 v[60:63], v[20:23], v[204:207], v[60:63]
    s_waitcnt vmcnt(8)
    v_perm_b32 v192, v132, v128, s90
    v_perm_b32 v193, v140, v136, s90
    v_perm_b32 v194, v148, v144, s90
    v_perm_b32 v195, v156, v152, s90
    s_nop 1
    v_mfma_f32_16x16x32_bf16 v[32:35], v[24:27], v[192:195], v[32:35]
    v_perm_b32 v196, v132, v128, s91
    v_perm_b32 v197, v140, v136, s91
    v_perm_b32 v198, v148, v144, s91
    v_perm_b32 v199, v156, v152, s91
    s_nop 1
    v_mfma_f32_16x16x32_bf16 v[36:39], v[24:27], v[196:199], v[36:39]
    v_perm_b32 v200, v133, v129, s90
    v_perm_b32 v201, v141, v137, s90
    v_perm_b32 v202, v149, v145, s90
    v_perm_b32 v203, v157, v153, s90
    s_nop 1
    v_mfma_f32_16x16x32_bf16 v[40:43], v[24:27], v[200:203], v[40:43]
    v_perm_b32 v204, v133, v129, s91
    v_perm_b32 v205, v141, v137, s91
    v_perm_b32 v206, v149, v145, s91
    v_perm_b32 v207, v157, v153, s91
    s_nop 1
    v_mfma_f32_16x16x32_bf16 v[44:47], v[24:27], v[204:207], v[44:47]
    v_perm_b32 v192, v134, v130, s90
    v_perm_b32 v193, v142, v138, s90
    v_perm_b32 v194, v150, v146, s90
    v_perm_b32 v195, v158, v154, s90
    s_nop 1
    v_mfma_f32_16x16x32_bf16 v[48:51], v[24:27], v[192:195], v[48:51]
    v_perm_b32 v196, v134, v130, s91
    v_perm_b32 v197, v142, v138, s91
    v_perm_b32 v198, v150, v146, s91
    v_perm_b32 v199, v158, v154, s91
    s_nop 1
    v_mfma_f32_16x16x32_bf16 v[52:55], v[24:27], v[196:199], v[52:55]
    v_perm_b32 v200, v135, v131, s90
    v_perm_b32 v201, v143, v139, s90
    v_perm_b32 v202, v151, v147, s90
    v_perm_b32 v203, v159, v155, s90
    s_nop 1
    v_mfma_f32_16x16x32_bf16 v[56:59], v[24:27], v[200:203], v[56:59]
    v_perm_b32 v204, v135, v131, s91
    v_perm_b32 v205, v143, v139, s91
    v_perm_b32 v206, v151, v147, s91
    v_perm_b32 v207, v159, v155, s91
    s_nop 1
    v_mfma_f32_16x16x32_bf16 v[60:63], v[24:27], v[204:207], v[60:63]
    s_waitcnt vmcnt(0)
    v_perm_b32 v192, v164, v160, s90
    v_perm_b32 v193, v172, v168, s90
    v_perm_b32 v194, v180, v176, s90
    v_perm_b32 v195, v188, v184, s90
    s_nop 1
    v_mfma_f32_16x16x32_bf16 v[32:35], v[28:31], v[192:195], v[32:35]
    v_perm_b32 v196, v164, v160, s91
    v_perm_b32 v197, v172, v168, s91
    v_perm_b32 v198, v180, v176, s91
    v_perm_b32 v199, v188, v184, s91
    s_nop 1
    v_mfma_f32_16x16x32_bf16 v[36:39], v[28:31], v[196:199], v[36:39]
    v_perm_b32 v200, v165, v161, s90
    v_perm_b32 v201, v173, v169, s90
    v_perm_b32 v202, v181, v177, s90
    v_perm_b32 v203, v189, v185, s90
    s_nop 1
    v_mfma_f32_16x16x32_bf16 v[40:43], v[28:31], v[200:203], v[40:43]
    v_perm_b32 v204, v165, v161, s91
    v_perm_b32 v205, v173, v169, s91
    v_perm_b32 v206, v181, v177, s91
    v_perm_b32 v207, v189, v185, s91
    s_nop 1
    v_mfma_f32_16x16x32_bf16 v[44:47], v[28:31], v[204:207], v[44:47]
    v_perm_b32 v192, v166, v162, s90
    v_perm_b32 v193, v174, v170, s90
    v_perm_b32 v194, v182, v178, s90
    v_perm_b32 v195, v190, v186, s90
    s_nop 1
    v_mfma_f32_16x16x32_bf16 v[48:51], v[28:31], v[192:195], v[48:51]
    v_perm_b32 v196, v166, v162, s91
    v_perm_b32 v197, v174, v170, s91
    v_perm_b32 v198, v182, v178, s91
    v_perm_b32 v199, v190, v186, s91
    s_nop 1
    v_mfma_f32_16x16x32_bf16 v[52:55], v[28:31], v[196:199], v[52:55]
    v_perm_b32 v200, v167, v163, s90
    v_perm_b32 v201, v175, v171, s90
    v_perm_b32 v202, v183, v179, s90
    v_perm_b32 v203, v191, v187, s90
    s_nop 1
    v_mfma_f32_16x16x32_bf16 v[56:59], v[28:31], v[200:203], v[56:59]
    v_perm_b32 v204, v167, v163, s91
    v_perm_b32 v205, v175, v171, s91
    v_perm_b32 v206, v183, v179, s91
    v_perm_b32 v207, v191, v187, s91
    s_nop 1
    v_mfma_f32_16x16x32_bf16 v[60:63], v[28:31], v[204:207], v[60:63]
    s_nop 7
    v_add_f32_dpp v64, v34, v32 row_ror:8 row_mask:0xf bank_mask:0xf
    v_add_f32_dpp v65, v38, v36 row_ror:8 row_mask:0xf bank_mask:0xf
    v_add_f32_dpp v66, v42, v40 row_ror:8 row_mask:0xf bank_mask:0xf
    v_add_f32_dpp v67, v46, v44 row_ror:8 row_mask:0xf bank_mask:0xf
    v_add_f32_dpp v68, v50, v48 row_ror:8 row_mask:0xf bank_mask:0xf
    v_add_f32_dpp v69, v54, v52 row_ror:8 row_mask:0xf bank_mask:0xf
    v_add_f32_dpp v70, v58, v56 row_ror:8 row_mask:0xf bank_mask:0xf
    v_add_f32_dpp v71, v62, v60 row_ror:8 row_mask:0xf bank_mask:0xf
    v_add_f32_dpp v72, v35, v33 row_ror:8 row_mask:0xf bank_mask:0xf
    v_add_f32_dpp v73, v39, v37 row_ror:8 row_mask:0xf bank_mask:0xf
    v_add_f32_dpp v74, v43, v41 row_ror:8 row_mask:0xf bank_mask:0xf
    v_add_f32_dpp v75, v47, v45 row_ror:8 row_mask:0xf bank_mask:0xf
    v_add_f32_dpp v76, v51, v49 row_ror:8 row_mask:0xf bank_mask:0xf
    v_add_f32_dpp v77, v55, v53 row_ror:8 row_mask:0xf bank_mask:0xf
    v_add_f32_dpp v78, v59, v57 row_ror:8 row_mask:0xf bank_mask:0xf
    v_add_f32_dpp v79, v63, v61 row_ror:8 row_mask:0xf bank_mask:0xf
    v_min_u32 v64, -2, v64
    v_min_u32 v65, -2, v65
    v_min_u32 v66, -2, v66
    v_min_u32 v67, -2, v67
    v_min_u32 v68, -2, v68
    v_min_u32 v69, -2, v69
    v_min_u32 v70, -2, v70
    v_min_u32 v71, -2, v71
    v_min_u32 v72, -2, v72
    v_min_u32 v73, -2, v73
    v_min_u32 v74, -2, v74
    v_min_u32 v75, -2, v75
    v_min_u32 v76, -2, v76
    v_min_u32 v77, -2, v77
    v_min_u32 v78, -2, v78
    v_min_u32 v79, -2, v79
    v_mov_b32 v7, 135168
    s_mov_b32 s60, 400000
L_h0_flag1:
    ds_read_b32 v8, v7
    s_waitcnt lgkmcnt(0)
    v_cmp_le_u32 vcc, 1, v8
    s_cbranch_vccnz L_h0_flag1_ok
    s_sleep 1
    s_sub_u32 s60, s60, 1
    s_cmp_lg_u32 s60, 0
    s_cbranch_scc1 L_h0_flag1
L_h0_flag1_ok:
    s_mov_b64 exec, 0xff
    buffer_store_dwordx4 v[64:67], v1, s[36:39], s52 offen sc1
    buffer_store_dwordx4 v[68:71], v1, s[36:39], s52 offen offset:128 sc1
    buffer_store_dwordx4 v[72:75], v1, s[36:39], s53 offen sc1
    buffer_store_dwordx4 v[76:79], v1, s[36:39], s53 offen offset:128 sc1
    s_mov_b64 exec, -1
    s_mov_b32 s60, 400000
    s_bfe_u32 s21, s2, 0x10005
    s_lshl_b32 s24, s21, 14
    s_lshl_b32 s25, s20, 12
    s_add_u32 s52, s24, s25
    s_add_u32 s53, s52, 32768
    s_add_u32 s54, s52, 65536
    s_add_u32 s55, s52, 98304
    v_and_b32 v6, 7, v0
    v_lshlrev_b32 v6, 4, v6
    v_lshl_add_u32 v6, v4, 7, v6
    v_bfe_u32 v7, v0, 3, 1
    v_lshl_add_u32 v6, v7, 3, v6
    v_add_u32 v6, 131072, v6
    v_mov_b32 v7, 135168
L_h0_flag2:
    ds_read_b32 v8, v7 offset:4
    s_waitcnt lgkmcnt(0)
    v_cmp_eq_u32 vcc, 1, v8
    s_cbranch_vccnz L_h0_flag2_ok
    s_sleep 2
    s_sub_u32 s60, s60, 1
    s_cmp_lg_u32 s60, 0
    s_cbranch_scc1 L_h0_flag2
L_h0_flag2_ok:
    s_mov_b32 s60, 400000
    v_and_b32 v12, 3, v0
    v_lshlrev_b32 v12, 6, v12
    s_mov_b64 exec, 0xf
L_h0_poll:
    global_load_dword v8, v12, s[16:17] sc1
    s_waitcnt vmcnt(0)
    v_cmp_gt_u32 vcc, 64, v8
    s_cbranch_vccz L_h0_flag_ok
    s_sleep 16
    s_sub_u32 s60, s60, 1
    s_cmp_lg_u32 s60, 0
    s_cbranch_scc1 L_h0_poll
L_h0_flag_ok:
    s_mov_b64 exec, -1
    s_mov_b32 s60, 400000
L_h1_gather:
    buffer_load_dwordx4 v[16:19], v1, s[36:39], s52 offen offset:0 sc1
    buffer_load_dwordx4 v[20:23], v1, s[36:39], s52 offen offset:1024 sc1
    buffer_load_dwordx4 v[24:27], v1, s[36:39], s52 offen offset:2048 sc1
    buffer_load_dwordx4 v[28:31], v1, s[36:39], s52 offen offset:3072 sc1
    buffer_load_dwordx4 v[32:35], v1, s[36:39], s53 offen offset:0 sc1
    buffer_load_dwordx4 v[36:39], v1, s[36:39], s53 offen offset:1024 sc1
    buffer_load_dwordx4 v[40:43], v1, s[36:39], s53 offen offset:2048 sc1
    buffer_load_dwordx4 v[44:47], v1, s[36:39], s53 offen offset:3072 sc1
    buffer_load_dwordx4 v[48:51], v1, s[36:39], s54 offen offset:0 sc1
    buffer_load_dwordx4 v[52:55], v1, s[36:39], s54 offen offset:1024 sc1
    buffer_load_dwordx4 v[56:59], v1, s[36:39], s54 offen offset:2048 sc1
    buffer_load_dwordx4 v[60:63], v1, s[36:39], s54 offen offset:3072 sc1
    buffer_load_dwordx4 v[64:67], v1, s[36:39], s55 offen offset:0 sc1
    buffer_load_dwordx4 v[68:71], v1, s[36:39], s55 offen offset:1024 sc1
    buffer_load_dwordx4 v[72:75], v1, s[36:39], s55 offen offset:2048 sc1
    buffer_load_dwordx4 v[76:79], v1, s[36:39], s55 offen offset:3072 sc1
    s_waitcnt vmcnt(0)
    v_max3_u32 v8, v16, v17, v18
    v_max3_u32 v9, v19, v20, v21
    v_max3_u32 v8, v8, v22, v23
    v_max3_u32 v9, v9, v24, v25
    v_max3_u32 v8, v8, v26, v27
    v_max3_u32 v9, v9, v28, v29
    v_max3_u32 v8, v8, v30, v31
    v_max3_u32 v9, v9, v32, v33
    v_max3_u32 v8, v8, v34, v35
    v_max3_u32 v9, v9, v36, v37
    v_max3_u32 v8, v8, v38, v39
    v_max3_u32 v9, v9, v40, v41
    v_max3_u32 v8, v8, v42, v43
    v_max3_u32 v9, v9, v44, v45
    v_max3_u32 v8, v8, v46, v47
    v_max3_u32 v9, v9, v48, v49
    v_max3_u32 v8, v8, v50, v51
    v_max3_u32 v9, v9, v52, v53
    v_max3_u32 v8, v8, v54, v55
    v_max3_u32 v9, v9, v56, v57
    v_max3_u32 v8, v8, v58, v59
    v_max3_u32 v9, v9, v60, v61
    v_max3_u32 v8, v8, v62, v63
    v_max3_u32 v9, v9, v64, v65
    v_max3_u32 v8, v8, v66, v67
    v_max3_u32 v9, v9, v68, v69
    v_max3_u32 v8, v8, v70, v71
    v_max3_u32 v9, v9, v72, v73
    v_max3_u32 v8, v8, v74, v75
    v_max3_u32 v9, v9, v76, v77
    v_max3_u32 v8, v8, v78, v79
    v_max_u32 v8, v8, v9
    v_cmp_eq_u32 vcc, -1, v8
    s_cbranch_vccz L_h1_got
    s_sleep 16
    s_sub_u32 s60, s60, 1
    s_cmp_lg_u32 s60, 0
    s_cbranch_scc1 L_h1_gather
L_h1_got:
    v_add_f32 v16, v16, v32
    v_add_f32 v48, v48, v64
    v_add_f32 v17, v17, v33
    v_add_f32 v49, v49, v65
    v_add_f32 v18, v18, v34
    v_add_f32 v50, v50, v66
    v_add_f32 v19, v19, v35
    v_add_f32 v51, v51, v67
    v_add_f32 v20, v20, v36
    v_add_f32 v52, v52, v68
    v_add_f32 v21, v21, v37
    v_add_f32 v53, v53, v69
    v_add_f32 v22, v22, v38
    v_add_f32 v54, v54, v70
    v_add_f32 v23, v23, v39
    v_add_f32 v55, v55, v71
    v_add_f32 v24, v24, v40
    v_add_f32 v56, v56, v72
    v_add_f32 v25, v25, v41
    v_add_f32 v57, v57, v73
    v_add_f32 v26, v26, v42
    v_add_f32 v58, v58, v74
    v_add_f32 v27, v27, v43
    v_add_f32 v59, v59, v75
    v_add_f32 v28, v28, v44
    v_add_f32 v60, v60, v76
    v_add_f32 v29, v29, v45
    v_add_f32 v61, v61, v77
    v_add_f32 v30, v30, v46
    v_add_f32 v62, v62, v78
    v_add_f32 v31, v31, v47
    v_add_f32 v63, v63, v79
    v_add_f32 v16, v16, v48
    v_add_f32 v17, v17, v49
    v_add_f32 v18, v18, v50
    v_add_f32 v19, v19, v51
    v_add_f32 v20, v20, v52
    v_add_f32 v21, v21, v53
    v_add_f32 v22, v22, v54
    v_add_f32 v23, v23, v55
    v_add_f32 v24, v24, v56
    v_add_f32 v25, v25, v57
    v_add_f32 v26, v26, v58
    v_add_f32 v27, v27, v59
    v_add_f32 v28, v28, v60
    v_add_f32 v29, v29, v61
    v_add_f32 v30, v30, v62
    v_add_f32 v31, v31, v63
    v_cvt_pk_bf16_f32 v16, v16, v17
    v_cvt_pk_bf16_f32 v17, v18, v19
    v_cvt_pk_bf16_f32 v18, v20, v21
    v_cvt_pk_bf16_f32 v19, v22, v23
    v_cvt_pk_bf16_f32 v20, v24, v25
    v_cvt_pk_bf16_f32 v21, v26, v27
    v_cvt_pk_bf16_f32 v22, v28, v29
    v_cvt_pk_bf16_f32 v23, v30, v31
    ds_write_b64 v6, v[16:17] offset:0
    ds_write_b64 v6, v[18:19] offset:512
    ds_write_b64 v6, v[20:21] offset:1024
    ds_write_b64 v6, v[22:23] offset:1536
    s_waitcnt lgkmcnt(0)
L_h_notq:
    s_setprio 0
    s_barrier
    s_mov_b32 s28, s12
    s_and_b32 s29, s13, 0xffff
    s_mov_b32 s30, 0x800000
    s_mov_b32 s31, 0x20000
    s_mov_b32 s32, s14
    s_and_b32 s33, s15, 0xffff
    s_mov_b32 s34, 0x1000
    s_mov_b32 s35, 0x20000
    v_lshlrev_b32 v1, 4, v3
    v_lshl_add_u32 v1, v4, 12, v1
    s_lshl_b32 s24, s48, 16
    s_lshl_b32 s25, s46, 10
    s_add_u32 s24, s24, s25
    s_lshl_b32 s25, s23, 8
    s_add_u32 s24, s24, s25
    s_add_u32 s25, s24, 0
    buffer_load_dwordx4 v[64:67], v1, s[28:31], s25 offen nt
    s_add_u32 s25, s24, 16384
    buffer_load_dwordx4 v[68:71], v1, s[28:31], s25 offen nt
    s_add_u32 s25, s24, 32768
    buffer_load_dwordx4 v[72:75], v1, s[28:31], s25 offen nt
    s_add_u32 s25, s24, 49152
    buffer_load_dwordx4 v[76:79], v1, s[28:31], s25 offen nt
    s_add_u32 s25, s24, 2048
    buffer_load_dwordx4 v[80:83], v1, s[28:31], s25 offen nt
    s_add_u32 s25, s24, 18432
    buffer_load_dwordx4 v[84:87], v1, s[28:31], s25 offen nt
    s_add_u32 s25, s24, 34816
    buffer_load_dwordx4 v[88:91], v1, s[28:31], s25 offen nt
    s_add_u32 s25, s24, 51200
    buffer_load_dwordx4 v[92:95], v1, s[28:31], s25 offen nt
    v_bfe_u32 v5, v0, 3, 1
    v_lshl_add_u32 v5, v5, 5, v4
    v_and_b32 v7, 7, v0
    v_lshlrev_b32 v6, 12, v5
    v_lshl_add_u32 v6, v7, 4, v6
    v_lshlrev_b32 v7, 6, v5
    s_lshl_b32 s24, s20, 18
    s_lshl_b32 s25, s47, 7
    s_add_u32 s24, s24, s25
    s_lshl_b32 s25, s23, 15
    s_add_u32 s24, s24, s25
    s_add_u32 s40, s24, 0x20000
    s_add_u32 s41, s40, 16384
    s_lshl_b32 s26, s20, 12
    s_lshr_b32 s25, s47, 2
    s_lshl_b32 s25, s25, 3
    s_add_u32 s26, s26, s25
    s_lshl_b32 s25, s23, 9
    s_add_u32 s26, s26, s25
    s_add_u32 s26, s26, 0x120000
    v_lshlrev_b32 v8, 4, v3
    s_lshl_b32 s25, s23, 9
    s_add_u32 s25, s25, 135168
    v_add_u32 v8, s25, v8
    v_bfe_u32 v9, v0, 3, 1
    v_lshlrev_b32 v9, 3, v9
    v_add_u32 v9, s25, v9
    v_and_b32 v10, 1, v0
    v_lshlrev_b32 v11, 3, v10
    v_add_u32 v11, 135168, v11
    v_lshlrev_b32 v10, 7, v10
    v_lshl_add_u32 v10, v4, 5, v10
    v_add_u32 v10, 135168, v10
    v_lshlrev_b32 v12, 4, v3
    s_lshl_b32 s44, s48, 13
    s_lshl_b32 s25, s46, 11
    s_add_u32 s44, s44, s25
    s_lshl_b32 s25, s23, 9
    s_add_u32 s44, s44, s25
    s_add_u32 s44, s44, 0x124000
    s_add_u32 s45, s44, 4096
    s_mov_b64 s[50:51], -1
    s_mov_b64 s[52:53], -1
    s_mov_b64 s[54:55], -1
    s_mov_b64 s[56:57], -1
    s_mov_b32 s60, 400000
    s_waitcnt vmcnt(0)
    v_perm_b32 v96, v68, v64, s90
    v_perm_b32 v97, v76, v72, s90
    v_perm_b32 v98, v84, v80, s90
    v_perm_b32 v99, v92, v88, s90
    v_perm_b32 v100, v68, v64, s91
    v_perm_b32 v101, v76, v72, s91
    v_perm_b32 v102, v84, v80, s91
    v_perm_b32 v103, v92, v88, s91
    v_perm_b32 v104, v69, v65, s90
    v_perm_b32 v105, v77, v73, s90
    v_perm_b32 v106, v85, v81, s90
    v_perm_b32 v107, v93, v89, s90
    v_perm_b32 v108, v69, v65, s91
    v_perm_b32 v109, v77, v73, s91
    v_perm_b32 v110, v85, v81, s91
    v_perm_b32 v111, v93, v89, s91
    v_perm_b32 v112, v70, v66, s90
    v_perm_b32 v113, v78, v74, s90
    v_perm_b32 v114, v86, v82, s90
    v_perm_b32 v115, v94, v90, s90
    v_perm_b32 v116, v70, v66, s91
    v_perm_b32 v117, v78, v74, s91
    v_perm_b32 v118, v86, v82, s91
    v_perm_b32 v119, v94, v90, s91
    v_perm_b32 v120, v71, v67, s90
    v_perm_b32 v121, v79, v75, s90
    v_perm_b32 v122, v87, v83, s90
    v_perm_b32 v123, v95, v91, s90
    v_perm_b32 v124, v71, v67, s91
    v_perm_b32 v125, v79, v75, s91
    v_perm_b32 v126, v87, v83, s91
    v_perm_b32 v127, v95, v91, s91
    v_mov_b32 v176, -1
    v_mov_b32 v177, -1
    v_mov_b32 v178, -1
    v_mov_b32 v179, -1
    v_mov_b32 v180, -1
    v_mov_b32 v181, -1
    v_mov_b32 v182, -1
    v_mov_b32 v183, -1
    v_mov_b32 v184, -1
    v_mov_b32 v185, -1
    v_mov_b32 v186, -1
    v_mov_b32 v187, -1
    s_mov_b64 s[50:51], -1
    s_mov_b32 s60, 400000
    v_and_b32 v13, 7, v0
    v_lshlrev_b32 v13, 3, v13
    v_add_u32 v14, 133120, v13
    s_lshl_b32 s42, s2, 6
    s_add_u32 s42, s42, 0x120000
    s_cmp_lg_u32 s23, 2
    s_cbranch_scc1 L_no_tk
    s_setprio 3
    s_lshr_b32 s24, s2, 5
    s_lshl_b32 s24, s24, 12
    s_add_u32 s24, s24, 0x244000
    v_mov_b32 v21, s24
    v_mov_b32 v22, 1
    v_mov_b32 v23, 133504
    v_mov_b32 v24, 133632
    s_mov_b32 s61, 0
    s_mov_b32 s59, 1600000
    s_mov_b64 exec, 1
L_tk:
    ds_read_b32 v20, v23
    s_waitcnt lgkmcnt(0)
    v_readfirstlane_b32 s24, v20
    s_cmp_gt_u32 s24, s61
    s_cbranch_scc1 L_tk_go
    s_sleep 1
    s_sub_u32 s59, s59, 1
    s_cmp_lg_u32 s59, 0
    s_cbranch_scc1 L_tk
    s_branch L_tk_end
L_tk_go:
    global_atomic_add v20, v21, v22, s[18:19] sc0 sc1
    s_add_u32 s61, s61, 1
    s_waitcnt vmcnt(0)
    ds_write_b32 v24, v20
    v_add_u32 v24, 4, v24
    v_readfirstlane_b32 s24, v20
    s_cmp_lt_u32 s24, 128
    s_cbranch_scc1 L_tk
L_tk_end:
    s_mov_b64 exec, -1
    s_waitcnt lgkmcnt(0)
L_no_tk:
    s_barrier
    s_cmp_lg_u32 s23, 3
    s_cbranch_scc1 L_no_ml
    ds_read_b64 v[40:41], v14 offset:0
    ds_read_b64 v[42:43], v14 offset:64
    ds_read_b64 v[44:45], v14 offset:128
    ds_read_b64 v[46:47], v14 offset:192
    s_waitcnt lgkmcnt(0)
    v_max_f32 v32, v40, v42
    v_max3_f32 v32, v32, v44, v46
    v_sub_f32 v40, v40, v32
    v_sub_f32 v42, v42, v32
    v_sub_f32 v44, v44, v32
    v_sub_f32 v46, v46, v32
    v_exp_f32 v40, v40
    v_exp_f32 v42, v42
    v_exp_f32 v44, v44
    v_exp_f32 v46, v46
    v_min_u32 v32, -2, v32
    v_mul_f32 v33, v40, v41
    v_fmac_f32 v33, v42, v43
    v_fmac_f32 v33, v44, v45
    v_fmac_f32 v33, v46, v47
    v_min_u32 v33, -2, v33
    s_mov_b64 exec, 0xff
    buffer_store_dwordx2 v[32:33], v13, s[36:39], s42 offen sc1
    s_mov_b64 exec, -1
L_no_ml:
    s_barrier
    buffer_load_dwordx4 v[160:163], v6, s[36:39], s40 offen sc1
    buffer_load_dwordx2 v[168:169], v7, s[36:39], s26 offen offset:0 sc1
    buffer_load_dwordx4 v[164:167], v6, s[36:39], s41 offen sc1
    buffer_load_dwordx2 v[170:171], v7, s[36:39], s26 offen offset:256 sc1
    s_sleep 6
L_s2_loop:
    buffer_load_dwordx4 v[176:179], v6, s[36:39], s40 offen sc1
    buffer_load_dwordx2 v[184:185], v7, s[36:39], s26 offen offset:0 sc1
    buffer_load_dwordx4 v[180:183], v6, s[36:39], s41 offen sc1
    buffer_load_dwordx2 v[186:187], v7, s[36:39], s26 offen offset:256 sc1
    s_mov_b64 exec, -1
    s_waitcnt vmcnt(4)
    v_max3_u32 v28, v160, v161, v162
    v_max3_u32 v29, v163, v164, v165
    v_max3_u32 v28, v28, v166, v167
    v_max3_u32 v29, v29, v168, v169
    v_max3_u32 v28, v28, v170, v171
    v_max_u32 v28, v28, v29
    v_cmp_eq_u32 s[50:51], -1, v28
    s_mov_b64 exec, s[50:51]
    s_cbranch_execz L_s2_ok
    buffer_load_dwordx4 v[160:163], v6, s[36:39], s40 offen sc1
    buffer_load_dwordx2 v[168:169], v7, s[36:39], s26 offen offset:0 sc1
    buffer_load_dwordx4 v[164:167], v6, s[36:39], s41 offen sc1
    buffer_load_dwordx2 v[170:171], v7, s[36:39], s26 offen offset:256 sc1
    s_mov_b64 exec, -1
    s_waitcnt vmcnt(4)
    v_max3_u32 v28, v176, v177, v178
    v_max3_u32 v29, v179, v180, v181
    v_max3_u32 v28, v28, v182, v183
    v_max3_u32 v29, v29, v184, v185
    v_max3_u32 v28, v28, v186, v187
    v_max_u32 v28, v28, v29
    v_cmp_ne_u32 vcc, -1, v28
    s_and_b64 exec, vcc, s[50:51]
    v_mov_b32 v160, v176
    v_mov_b32 v161, v177
    v_mov_b32 v162, v178
    v_mov_b32 v163, v179
    v_mov_b32 v164, v180
    v_mov_b32 v165, v181
    v_mov_b32 v166, v182
    v_mov_b32 v167, v183
    v_mov_b32 v168, v184
    v_mov_b32 v169, v185
    v_mov_b32 v170, v186
    v_mov_b32 v171, v187
    s_andn2_b64 exec, s[50:51], vcc
    s_cbranch_execz L_s2_ok
    s_sub_u32 s60, s60, 1
    s_cmp_lg_u32 s60, 0
    s_cbranch_scc1 L_s2_loop
L_s2_ok:
    s_mov_b64 exec, -1
    v_max_f32 v32, v168, v170
    s_nop 0
    v_mov_b32 v33, v32
    s_nop 1
    v_permlane16_swap_b32 v32, v33
    s_nop 1
    v_max_f32 v32, v32, v33
    s_nop 0
    v_mov_b32 v33, v32
    s_nop 1
    v_permlane32_swap_b32 v32, v33
    s_nop 1
    v_max_f32 v32, v32, v33
    v_sub_f32 v24, v168, v32
    v_sub_f32 v26, v170, v32
    v_exp_f32 v24, v24
    v_exp_f32 v26, v26
    s_nop 0
    v_mul_f32 v33, v24, v169
    v_mul_f32 v36, v24, v160
    v_mul_f32 v37, v24, v161
    v_mul_f32 v38, v24, v162
    v_mul_f32 v39, v24, v163
    v_fmac_f32 v33, v26, v171
    v_fmac_f32 v36, v26, v164
    v_fmac_f32 v37, v26, v165
    v_fmac_f32 v38, v26, v166
    v_fmac_f32 v39, v26, v167
    v_mov_b32 v40, v33
    v_mov_b32 v41, v36
    v_mov_b32 v42, v37
    v_mov_b32 v43, v38
    v_mov_b32 v44, v39
    s_nop 0
    v_permlane16_swap_b32 v33, v40
    v_permlane16_swap_b32 v36, v41
    v_permlane16_swap_b32 v37, v42
    v_permlane16_swap_b32 v38, v43
    v_permlane16_swap_b32 v39, v44
    s_nop 0
    v_add_f32 v33, v33, v40
    v_add_f32 v36, v36, v41
    v_add_f32 v37, v37, v42
    v_add_f32 v38, v38, v43
    v_add_f32 v39, v39, v44
    v_mov_b32 v40, v33
    v_mov_b32 v41, v36
    v_mov_b32 v42, v37
    v_mov_b32 v43, v38
    v_mov_b32 v44, v39
    s_nop 0
    v_permlane32_swap_b32 v33, v40
    v_permlane32_swap_b32 v36, v41
    v_permlane32_swap_b32 v37, v42
    v_permlane32_swap_b32 v38, v43
    v_permlane32_swap_b32 v39, v44
    s_nop 0
    v_add_f32 v33, v33, v40
    v_add_f32 v36, v36, v41
    v_add_f32 v37, v37, v42
    v_add_f32 v38, v38, v43
    v_add_f32 v39, v39, v44
    s_mov_b64 exec, 0xffff
    ds_write_b128 v8, v[36:39]
    s_mov_b64 exec, 0x101
    ds_write_b64 v9, v[32:33] offset:256
    s_mov_b64 exec, -1
    s_waitcnt lgkmcnt(0)
    s_barrier
    ds_read_b64 v[16:17], v11 offset:256
    ds_read_b64 v[18:19], v11 offset:768
    ds_read_b64 v[20:21], v11 offset:1280
    ds_read_b64 v[22:23], v11 offset:1792
    ds_read_b128 v[24:27], v10 offset:0
    ds_read_b128 v[28:31], v10 offset:16
    ds_read_b128 v[32:35], v10 offset:512
    ds_read_b128 v[36:39], v10 offset:528
    ds_read_b128 v[40:43], v10 offset:1024
    ds_read_b128 v[44:47], v10 offset:1040
    ds_read_b128 v[48:51], v10 offset:1536
    ds_read_b128 v[52:55], v10 offset:1552
    s_waitcnt lgkmcnt(8)
    v_max_f32 v56, v16, v18
    v_max3_f32 v56, v56, v20, v22
    v_sub_f32 v16, v16, v56
    v_sub_f32 v18, v18, v56
    v_sub_f32 v20, v20, v56
    v_sub_f32 v22, v22, v56
    v_exp_f32 v16, v16
    v_exp_f32 v18, v18
    v_exp_f32 v20, v20
    v_exp_f32 v22, v22
    s_nop 0
    v_mul_f32 v57, v16, v17
    v_fmac_f32 v57, v18, v19
    v_fmac_f32 v57, v20, v21
    v_fmac_f32 v57, v22, v23
    v_rcp_f32 v57, v57
    s_nop 0
    v_mul_f32 v16, v16, v57
    v_mul_f32 v18, v18, v57
    v_mul_f32 v20, v20, v57
    v_mul_f32 v22, v22, v57
    s_waitcnt lgkmcnt(0)
    v_mul_f32 v24, v16, v24
    v_mul_f32 v25, v16, v25
    v_mul_f32 v26, v16, v26
    v_mul_f32 v27, v16, v27
    v_mul_f32 v28, v16, v28
    v_mul_f32 v29, v16, v29
    v_mul_f32 v30, v16, v30
    v_mul_f32 v31, v16, v31
    v_fmac_f32 v24, v18, v32
    v_fmac_f32 v25, v18, v33
    v_fmac_f32 v26, v18, v34
    v_fmac_f32 v27, v18, v35
    v_fmac_f32 v28, v18, v36
    v_fmac_f32 v29, v18, v37
    v_fmac_f32 v30, v18, v38
    v_fmac_f32 v31, v18, v39
    v_fmac_f32 v24, v20, v40
    v_fmac_f32 v25, v20, v41
    v_fmac_f32 v26, v20, v42
    v_fmac_f32 v27, v20, v43
    v_fmac_f32 v28, v20, v44
    v_fmac_f32 v29, v20, v45
    v_fmac_f32 v30, v20, v46
    v_fmac_f32 v31, v20, v47
    v_fmac_f32 v24, v22, v48
    v_fmac_f32 v25, v22, v49
    v_fmac_f32 v26, v22, v50
    v_fmac_f32 v27, v22, v51
    v_fmac_f32 v28, v22, v52
    v_fmac_f32 v29, v22, v53
    v_fmac_f32 v30, v22, v54
    v_fmac_f32 v31, v22, v55
    v_cvt_pk_bf16_f32 v60, v24, v25
    v_cvt_pk_bf16_f32 v61, v26, v27
    v_cvt_pk_bf16_f32 v62, v28, v29
    v_cvt_pk_bf16_f32 v63, v30, v31
    s_nop 1
    v_mfma_f32_16x16x32_bf16 v[128:131], v[60:63], v[96:99], 0
    v_mfma_f32_16x16x32_bf16 v[132:135], v[60:63], v[100:103], 0
    v_mfma_f32_16x16x32_bf16 v[136:139], v[60:63], v[104:107], 0
    v_mfma_f32_16x16x32_bf16 v[140:143], v[60:63], v[108:111], 0
    v_mfma_f32_16x16x32_bf16 v[144:147], v[60:63], v[112:115], 0
    v_mfma_f32_16x16x32_bf16 v[148:151], v[60:63], v[116:119], 0
    v_mfma_f32_16x16x32_bf16 v[152:155], v[60:63], v[120:123], 0
    v_mfma_f32_16x16x32_bf16 v[156:159], v[60:63], v[124:127], 0
    s_nop 1
    v_min_u32 v16, -2, v128
    v_min_u32 v24, -2, v129
    v_min_u32 v17, -2, v132
    v_min_u32 v25, -2, v133
    v_min_u32 v18, -2, v136
    v_min_u32 v26, -2, v137
    v_min_u32 v19, -2, v140
    v_min_u32 v27, -2, v141
    v_min_u32 v20, -2, v144
    v_min_u32 v28, -2, v145
    v_min_u32 v21, -2, v148
    v_min_u32 v29, -2, v149
    v_min_u32 v22, -2, v152
    v_min_u32 v30, -2, v153
    v_min_u32 v23, -2, v156
    v_min_u32 v31, -2, v157
    s_mov_b64 exec, 0xffff
    buffer_store_dwordx4 v[16:19], v12, s[36:39], s44 offen sc1
    buffer_store_dwordx4 v[20:23], v12, s[36:39], s44 offen offset:256 sc1
    buffer_store_dwordx4 v[24:27], v12, s[36:39], s45 offen sc1
    buffer_store_dwordx4 v[28:31], v12, s[36:39], s45 offen offset:256 sc1
    s_mov_b64 exec, -1
    s_cmp_ge_u32 s2, 64
    s_cbranch_scc1 L_h_end
    v_lshrrev_b32 v1, 3, v0
    v_and_b32 v2, 7, v0
    v_lshlrev_b32 v1, 13, v1
    v_lshl_add_u32 v1, v2, 4, v1
    s_lshl_b32 s24, s2, 7
    s_lshl_b32 s25, s23, 18
    s_add_u32 s24, s24, s25
    s_add_u32 s40, s24, 0x124000
    s_add_u32 s41, s40, 65536
    s_add_u32 s42, s40, 131072
    s_add_u32 s43, s40, 196608
    v_lshlrev_b32 v5, 4, v2
    v_add_u32 v5, 137216, v5
    s_lshl_b32 s25, s23, 7
    v_add_u32 v6, s25, v5
    s_lshr_b32 s24, s2, 2
    s_lshl_b32 s24, s24, 8
    s_and_b32 s25, s2, 1
    s_lshl_b32 s25, s25, 7
    s_add_u32 s24, s24, s25
    s_and_b32 s25, s2, 2
    s_lshl_b32 s25, s25, 2
    s_add_u32 s24, s24, s25
    v_lshlrev_b32 v7, 4, v2
    v_mov_b32 v208, -1
    v_mov_b32 v209, -1
    v_mov_b32 v210, -1
    v_mov_b32 v211, -1
    v_mov_b32 v212, -1
    v_mov_b32 v213, -1
    v_mov_b32 v214, -1
    v_mov_b32 v215, -1
    v_mov_b32 v216, -1
    v_mov_b32 v217, -1
    v_mov_b32 v218, -1
    v_mov_b32 v219, -1
    v_mov_b32 v220, -1
    v_mov_b32 v221, -1
    v_mov_b32 v222, -1
    v_mov_b32 v223, -1
    s_mov_b64 s[50:51], -1
    s_mov_b32 s60, 400000
    buffer_load_dwordx4 v[192:195], v1, s[36:39], s40 offen sc1
    buffer_load_dwordx4 v[196:199], v1, s[36:39], s41 offen sc1
    buffer_load_dwordx4 v[200:203], v1, s[36:39], s42 offen sc1
    buffer_load_dwordx4 v[204:207], v1, s[36:39], s43 offen sc1
    s_sleep 6
L_s3_loop:
    buffer_load_dwordx4 v[208:211], v1, s[36:39], s40 offen sc1
    buffer_load_dwordx4 v[212:215], v1, s[36:39], s41 offen sc1
    buffer_load_dwordx4 v[216:219], v1, s[36:39], s42 offen sc1
    buffer_load_dwordx4 v[220:223], v1, s[36:39], s43 offen sc1
    s_mov_b64 exec, -1
    s_waitcnt vmcnt(4)
    v_max3_u32 v48, v192, v193, v194
    v_max3_u32 v49, v195, v196, v197
    v_max3_u32 v48, v48, v198, v199
    v_max3_u32 v49, v49, v200, v201
    v_max3_u32 v48, v48, v202, v203
    v_max3_u32 v49, v49, v204, v205
    v_max3_u32 v48, v48, v206, v207
    v_max_u32 v48, v48, v49
    v_cmp_eq_u32 s[50:51], -1, v48
    s_mov_b64 exec, s[50:51]
    s_cbranch_execz L_s3_ok
    buffer_load_dwordx4 v[192:195], v1, s[36:39], s40 offen sc1
    buffer_load_dwordx4 v[196:199], v1, s[36:39], s41 offen sc1
    buffer_load_dwordx4 v[200:203], v1, s[36:39], s42 offen sc1
    buffer_load_dwordx4 v[204:207], v1, s[36:39], s43 offen sc1
    s_mov_b64 exec, -1
    s_waitcnt vmcnt(4)
    v_max3_u32 v48, v208, v209, v210
    v_max3_u32 v49, v211, v212, v213
    v_max3_u32 v48, v48, v214, v215
    v_max3_u32 v49, v49, v216, v217
    v_max3_u32 v48, v48, v218, v219
    v_max3_u32 v49, v49, v220, v221
    v_max3_u32 v48, v48, v222, v223
    v_max_u32 v48, v48, v49
    v_cmp_ne_u32 vcc, -1, v48
    s_and_b64 exec, vcc, s[50:51]
    v_mov_b32 v192, v208
    v_mov_b32 v193, v209
    v_mov_b32 v194, v210
    v_mov_b32 v195, v211
    v_mov_b32 v196, v212
    v_mov_b32 v197, v213
    v_mov_b32 v198, v214
    v_mov_b32 v199, v215
    v_mov_b32 v200, v216
    v_mov_b32 v201, v217
    v_mov_b32 v202, v218
    v_mov_b32 v203, v219
    v_mov_b32 v204, v220
    v_mov_b32 v205, v221
    v_mov_b32 v206, v222
    v_mov_b32 v207, v223
    s_andn2_b64 exec, s[50:51], vcc
    s_cbranch_execz L_s3_ok
    s_sub_u32 s60, s60, 1
    s_cmp_lg_u32 s60, 0
    s_cbranch_scc1 L_s3_loop
L_s3_ok:
    s_mov_b64 exec, -1
    v_add_f32 v32, v192, v196
    v_add_f32 v40, v200, v204
    v_add_f32 v33, v193, v197
    v_add_f32 v41, v201, v205
    v_add_f32 v34, v194, v198
    v_add_f32 v42, v202, v206
    v_add_f32 v35, v195, v199
    v_add_f32 v43, v203, v207
    v_add_f32 v32, v32, v40
    v_add_f32 v33, v33, v41
    v_add_f32 v34, v34, v42
    v_add_f32 v35, v35, v43
    s_nop 1
    v_add_f32_dpp v32, v32, v32 row_ror:8 row_mask:0xf bank_mask:0xf
    v_add_f32_dpp v33, v33, v33 row_ror:8 row_mask:0xf bank_mask:0xf
    v_add_f32_dpp v34, v34, v34 row_ror:8 row_mask:0xf bank_mask:0xf
    v_add_f32_dpp v35, v35, v35 row_ror:8 row_mask:0xf bank_mask:0xf
    v_mov_b32 v36, v32
    v_mov_b32 v37, v33
    v_mov_b32 v38, v34
    v_mov_b32 v39, v35
    s_nop 0
    v_permlane16_swap_b32 v32, v36
    v_permlane16_swap_b32 v33, v37
    v_permlane16_swap_b32 v34, v38
    v_permlane16_swap_b32 v35, v39
    s_nop 0
    v_add_f32 v32, v32, v36
    v_add_f32 v33, v33, v37
    v_add_f32 v34, v34, v38
    v_add_f32 v35, v35, v39
    v_mov_b32 v36, v32
    v_mov_b32 v37, v33
    v_mov_b32 v38, v34
    v_mov_b32 v39, v35
    s_nop 0
    v_permlane32_swap_b32 v32, v36
    v_permlane32_swap_b32 v33, v37
    v_permlane32_swap_b32 v34, v38
    v_permlane32_swap_b32 v35, v39
    s_nop 0
    v_add_f32 v32, v32, v36
    v_add_f32 v33, v33, v37
    v_add_f32 v34, v34, v38
    v_add_f32 v35, v35, v39
    s_mov_b64 exec, 0xff
    ds_write_b128 v6, v[32:35]
    s_waitcnt lgkmcnt(0)
    s_barrier
    s_cmp_lg_u32 s23, 0
    s_cbranch_scc1 L_h_end2
    ds_read_b128 v[32:35], v5 offset:0
    ds_read_b128 v[36:39], v5 offset:128
    ds_read_b128 v[40:43], v5 offset:256
    ds_read_b128 v[44:47], v5 offset:384
    s_waitcnt lgkmcnt(0)
    v_add_f32 v32, v32, v36
    v_add_f32 v40, v40, v44
    v_add_f32 v33, v33, v37
    v_add_f32 v41, v41, v45
    v_add_f32 v34, v34, v38
    v_add_f32 v42, v42, v46
    v_add_f32 v35, v35, v39
    v_add_f32 v43, v43, v47
    v_add_f32 v32, v32, v40
    v_add_f32 v33, v33, v41
    v_add_f32 v34, v34, v42
    v_add_f32 v35, v35, v43
    v_cvt_pk_bf16_f32 v32, v32, v33
    v_cvt_pk_bf16_f32 v33, v34, v35
    buffer_store_dwordx2 v[32:33], v7, s[32:35], s24 offen
L_h_end2:
    s_mov_b64 exec, -1
L_h_end:
L_done:
    s_endpgm
.section .rodata,"a"
.p2align 6
.amdhsa_kernel standalone__gqa_block_cached__decode_kernel
  .amdhsa_next_free_vgpr 256
  .amdhsa_next_free_sgpr 96
  .amdhsa_accum_offset 256
  .amdhsa_group_segment_fixed_size 0
  .amdhsa_kernarg_size 64
  .amdhsa_user_sgpr_count 2
  .amdhsa_user_sgpr_kernarg_segment_ptr 1
  .amdhsa_system_sgpr_workgroup_id_x 1
.end_amdhsa_kernel
```
